```python
import torch

def _softmax(x, axis=-1):
    return torch.softmax(x, dim=axis)
def _gelu(x):
    return torch.nn.functional.gelu(x, approximate="tanh")
def _silu(x):
    return torch.nn.functional.silu(x)
def _sigmoid(x):
    return torch.sigmoid(x)
def _layernorm(x, axis=-1, eps=1e-5):
    m = x.mean(dim=axis, keepdim=True)
    v = x.var(dim=axis, keepdim=True, unbiased=False)
    return (x - m) / torch.sqrt(v + eps)
def _scatter_add(tgt, idx, src, axis=0):
    return tgt.clone().index_add_(axis, idx, src)
def _segment_sum(src, seg, n):
    out = torch.zeros((n,) + src.shape[1:], dtype=src.dtype)
    return out.index_add_(0, seg, src)
def _pad(x, pw):
    flat = tuple(v for pair in reversed(pw) for v in pair)
    return torch.nn.functional.pad(x, flat)

kernel_name = 'sequential_preLN__sliding_local_dilated__dense_activation_silu__prompt'

def setup_inputs():

    _w = (lambda a: (lambda t: t.to(torch.bfloat16) if t.is_floating_point() else t)(torch.as_tensor(a)))
    def _A_setup():
        B, S, D = 1, 2048, 512
        return {
            "x": _w((lambda *s: torch.randn(*s, dtype=torch.bfloat16) * 0.05)(B, S, D)),
            "wqkv": _w((lambda *s: torch.randn(*s, dtype=torch.bfloat16) * 0.05)(D, 3 * D)),
            "wo": _w((lambda *s: torch.randn(*s, dtype=torch.bfloat16) * 0.05)(D, D)),
        }
    _A_in = _A_setup()

    def _B_setup():
        B, S, D, F = 1, 2048, 512, 1376
        return {
            "x": _w((lambda *s: torch.randn(*s, dtype=torch.bfloat16) * 0.05)(B, S, D)),
            "w1": _w((lambda *s: torch.randn(*s, dtype=torch.bfloat16) * 0.8)(D, F) * (D ** -0.5)),
            "w2": _w((lambda *s: torch.randn(*s, dtype=torch.bfloat16) * 0.8)(F, D) * (F ** -0.5)),
        }
    _B_in = _B_setup()

    return {
        "A_x": _A_in["x"],
        "A_wqkv": _A_in["wqkv"],
        "A_wo": _A_in["wo"],
        "B_x": _B_in["x"],
        "B_w1": _B_in["w1"],
        "B_w2": _B_in["w2"],
    }

def reference(A_x, A_wqkv, A_wo, B_x, B_w1, B_w2):
    def _A_ref(x, wqkv, wo):
        B, S, D = x.shape
        H = 32; Dh = D // H
        W, dil = 8, 2
        qkv = (lambda x, *d: x.permute(*d))((x @ wqkv).reshape(B, S, 3, H, Dh), 2, 0, 3, 1, 4)
        q, k, v = qkv[0], qkv[1], qkv[2]
        scale = Dh ** -0.5
        pos = torch.arange(S)
        off = torch.arange(W) * dil
        idx = pos[:, None] - off[None, :]
        mask = idx >= 0
        idx_c = torch.where(mask, idx, 0).reshape(-1)
        kg = k[:, :, idx_c, :].reshape(B, H, S, W, Dh)
        vg = v[:, :, idx_c, :].reshape(B, H, S, W, Dh)
        logits = torch.einsum("bhsd,bhswd->bhsw", q, kg) * scale
        logits = torch.where(mask[None, None, :, :], logits, -1e9)
        attn = _softmax(logits, axis=-1)
        o = torch.einsum("bhsw,bhswd->bhsd", attn, vg)
        return (lambda x, *d: x.permute(*d))(o, 0, 2, 1, 3).reshape(B, S, D) @ wo

    def _B_ref(x, w1, w2):
        h = torch.einsum("bsd,df->bsf", x, w1)
        h = _silu(h)
        out = torch.einsum("bsf,fd->bsd", h, w2)
        return out

    x = A_x
    h = x + _A_ref(_layernorm(x, axis=-1), A_wqkv, A_wo)
    h2 = h + _B_ref(_layernorm(h, axis=-1), B_w1, B_w2)
    return h2
```

```asm
; @launch grid=(256,1,1) block=(256,1,1) lds=163840
.amdgcn_target "amdgcn-amd-amdhsa--gfx950"
.text
.globl sequential_preLN__sliding_local_dilated__dense_activation_silu__prompt_kernel
.p2align 8
.type sequential_preLN__sliding_local_dilated__dense_activation_silu__prompt_kernel,@function
sequential_preLN__sliding_local_dilated__dense_activation_silu__prompt_kernel:
    s_lshr_b32 s3, s2, 8
    s_cbranch_scc1 L_end
    s_load_dwordx2 s[4:5], s[0:1], 0
    s_load_dwordx2 s[8:9], s[0:1], 8
    s_load_dwordx2 s[28:29], s[0:1], 64
    s_getpc_b64 s[40:41]
L_pc:
    s_lshr_b32 s3, s2, 3
    s_mov_b32 s42, L_code_end-L_pc
    s_mov_b32 s43, 0x20000
    s_lshl_b32 s48, s3, 10
    v_and_b32 v1, 7, v0
    v_lshl_add_u32 v1, v1, 7, s48
    buffer_load_dword v238, v1, s[40:43], 0 offen
    s_and_b32 s44, s2, 7
    s_and_b32 s45, s3, 7
    s_lshr_b32 s3, s3, 3
    s_lshl_b32 s44, s44, 2
    s_add_u32 s44, s44, s3
    v_lshrrev_b32 v2, 6, v0
    v_and_b32 v0, 63, v0
    v_readfirstlane_b32 s46, v2
    v_lshrrev_b32 v61, 3, v0
    v_and_b32 v62, 7, v0
    v_xor_b32 v57, v62, v61
    v_lshlrev_b32 v57, 4, v57
    v_lshl_add_u32 v57, v61, 10, v57
    s_lshl_b32 s49, s44, 16
    s_lshl_b32 s67, s46, 14
    s_add_u32 s67, s67, s49
    v_add_u32 v40, s67, v57
    v_add_u32 v41, 7168, v40
    s_lshl_b32 s50, s46, 11
    s_and_b32 s53, s44, 3
    s_lshl_b32 s53, s53, 8
    s_mov_b32 s6, 0x200000
    s_mov_b32 s7, s43
    s_mov_b32 m0, s50
    s_waitcnt lgkmcnt(0)
    buffer_load_dwordx4 v40, s[4:7], s53 offen lds
    buffer_load_dwordx4 v41, s[4:7], s53 offen offset:1024 lds
    s_add_u32 s62, s40, L_table-L_pc
    s_addc_u32 s63, s41, 0
    s_mul_i32 s42, s46, 49152
    s_lshl_b32 s41, s45, 7
    s_add_u32 s42, s42, s41
    v_lshl_add_u32 v3, v61, 10, s42
    v_lshlrev_b32 v2, 4, v62
    s_mov_b32 s41, 192
    v_bfe_u32 v60, s41, v61, 1
    v_lshlrev_b32 v60, 5, v60
    v_xor_b32 v60, v60, v2
    v_add_u32 v60, v60, v3
    v_mov_b32 v200, v60
    v_xor_b32 v60, 64, v60
    v_add_u32 v203, 21504, v60
    s_mov_b32 s41, 15
    v_bfe_u32 v60, s41, v61, 1
    v_lshlrev_b32 v60, 5, v60
    v_xor_b32 v60, v60, v2
    v_add_u32 v60, v60, v3
    v_add_u32 v201, 7168, v60
    v_xor_b32 v60, 64, v60
    v_add_u32 v204, 32768, v60
    s_mov_b32 s41, 252
    v_bfe_u32 v60, s41, v61, 1
    v_lshlrev_b32 v60, 5, v60
    v_xor_b32 v60, v60, v2
    v_add_u32 v60, v60, v3
    v_add_u32 v202, 14336, v60
    v_xor_b32 v60, 64, v60
    v_add_u32 v205, 39936, v60
    s_mul_i32 s51, s46, 6144
    s_mov_b32 s10, 0x180000
    s_mov_b32 s11, 0x20000
    s_add_u32 m0, s51, 10240
    s_mul_i32 s49, s53, 1536
    buffer_load_dwordx4 v200, s[8:11], s49 offen lds
    buffer_load_dwordx4 v201, s[8:11], s49 offen offset:1024 lds
    buffer_load_dwordx4 v202, s[8:11], s49 offen offset:2048 lds
    buffer_load_dwordx4 v203, s[8:11], s49 offen offset:3072 lds
    s_add_u32 m0, s51, 14336
    s_nop 0
    buffer_load_dwordx4 v204, s[8:11], s49 offen lds
    buffer_load_dwordx4 v205, s[8:11], s49 offen offset:1024 lds
    s_load_dwordx2 s[12:13], s[0:1], 16
    s_load_dwordx2 s[16:17], s[0:1], 32
    s_load_dwordx2 s[20:21], s[0:1], 40
    s_load_dwordx2 s[24:25], s[0:1], 48
    s_load_dwordx2 s[36:37], s[0:1], 56
    s_lshl_b32 s52, s46, 12
    s_and_b32 s3, s46, 1
    s_lshl_b32 s3, s3, 2
    v_add_u32 v58, s3, v61
    v_xor_b32 v58, v58, v62
    v_lshlrev_b32 v58, 4, v58
    v_lshl_add_u32 v58, v61, 10, v58
    s_lshl_b32 s3, s44, 16
    s_add_u32 s3, s3, s52
    s_sub_u32 s3, s3, 16384
    s_cmp_eq_u32 s44, 0
    s_cselect_b32 s3, 0x80000000, s3
    v_add_u32 v42, s3, v58
    s_lshl_b32 s56, s46, 9
    s_cmp_eq_u32 s46, 0
    s_cselect_b32 s54, 0xffffff00, -1
    s_mov_b32 s55, 0
    s_add_u32 m0, s56, 8192
    s_mov_b64 exec, s[54:55]
    buffer_load_dwordx4 v42, s[4:7], s53 offen lds
    s_mov_b64 exec, -1
    s_load_dwordx16 s[68:83], s[62:63], 0
    s_load_dwordx16 s[84:99], s[62:63], 64
    s_lshl_b32 s3, s2, 2
    s_add_u32 s3, s3, s46
    s_mul_i32 s3, s3, 1536
    v_mov_b32 v2, 0x80000000
    v_lshl_add_u32 v206, v0, 7, s3
    v_cmp_gt_u32 vcc, 12, v0
    s_nop 1
    v_cndmask_b32 v206, v2, v206, vcc
    s_lshl_b32 s3, s45, 2
    s_add_u32 s3, s3, s46
    s_mul_i32 s3, s3, 2560
    s_lshl_b32 s41, s44, 16
    s_add_u32 s3, s3, s41
    s_sub_u32 s3, s3, 16384
    v_lshl_add_u32 v6, v0, 7, s3
    v_cmp_gt_u32 vcc, 20, v0
    s_nop 1
    v_cndmask_b32 v6, v2, v6, vcc
    buffer_load_dword v238, v206, s[8:11], 0 offen sc1
    buffer_load_dword v238, v6, s[4:7], 0 offen sc1
    s_lshl_b32 s43, s2, 2
    s_add_u32 s43, s43, s46
    s_mul_i32 s42, s44, 393216
    s_add_u32 s28, s28, s42
    s_addc_u32 s29, s29, 0
    s_mov_b32 s30, 196608
    s_mov_b32 s31, 0x20000
    s_lshl_b32 s40, s45, 2
    s_add_u32 s40, s40, s46
    s_lshl_b32 s40, s40, 2
    v_mov_b32 v29, s40
    v_mov_b32 v2, 0
    buffer_store_dword v2, v29, s[28:31], 0 offen sc1
    s_mov_b32 s14, 524288
    s_mov_b32 s15, 0x20000
    s_mov_b32 s18, 1409024
    s_mov_b32 s19, 0x20000
    s_mov_b32 s22, 1409024
    s_mov_b32 s23, 0x20000
    s_mov_b32 s26, 2097152
    s_mov_b32 s27, 0x20000
    s_mov_b32 s38, 256
    s_mov_b32 s39, 0x20000
    s_mov_b32 s34, 176128
    s_mov_b32 s35, 0x20000
    v_lshlrev_b32 v1, 4, v0
    v_and_b32 v2, 15, v0
    v_lshrrev_b32 v3, 4, v0
    v_mov_b32 v64, 0x3f803f80
    v_mov_b32 v65, v64
    v_mov_b32 v66, v64
    v_mov_b32 v67, v64
    v_and_b32 v57, 3, v61
    v_mul_u32_u24 v57, 34816, v57
    v_lshl_add_u32 v57, v62, 4, v57
    v_add_u32 v57, 8192, v57
    ds_write_b128 v57, v[64:67]
    v_accvgpr_write_b32 a72, v64
    v_accvgpr_write_b32 a73, v64
    v_accvgpr_write_b32 a74, v64
    v_accvgpr_write_b32 a75, v64
    v_and_b32 v57, 7, v2
    v_lshrrev_b32 v58, 3, v2
    v_lshlrev_b32 v58, 10, v58
    v_lshl_add_u32 v58, v57, 7, v58
    v_xor_b32 v59, v3, v57
    v_lshl_add_u32 v45, v59, 4, v58
    v_xor_b32 v47, 64, v45
    v_add_u32 v46, 69632, v45
    v_add_u32 v48, 69632, v47
    v_add_u32 v49, s50, v45
    v_add_u32 v50, s50, v46
    v_add_u32 v51, s50, v47
    v_add_u32 v52, s50, v48
    v_lshrrev_b32 v57, 2, v2
    v_and_b32 v58, 3, v2
    v_and_b32 v59, 1, v3
    v_lshrrev_b32 v60, 1, v58
    v_and_b32 v63, 2, v57
    v_xor_b32 v60, v60, v63
    v_lshlrev_b32 v63, 2, v59
    v_xor_b32 v60, v60, v63
    v_lshlrev_b32 v60, 4, v60
    v_lshl_add_u32 v60, v57, 7, v60
    v_and_b32 v63, 1, v58
    v_lshl_add_u32 v60, v63, 3, v60
    v_lshl_add_u32 v19, v3, 10, v60
    s_lshl_b32 s40, s46, 5
    v_xor_b32 v60, s40, v60
    v_lshl_add_u32 v60, v57, 8, v60
    v_mul_u32_u24 v63, 3072, v3
    v_add_u32 v60, v60, v63
    v_add_u32 v55, 10240, v60
    v_add_u32 v56, 79872, v60
    s_add_u32 m0, s50, 34816
    s_add_u32 s48, s53, 256
    s_and_b32 s48, s48, 0x3ff
    buffer_load_dwordx4 v40, s[4:7], s48 offen lds
    buffer_load_dwordx4 v41, s[4:7], s48 offen offset:1024 lds
    s_add_u32 m0, s56, 43008
    s_mov_b64 exec, s[54:55]
    buffer_load_dwordx4 v42, s[4:7], s48 offen lds
    s_mov_b64 exec, -1
    s_add_u32 m0, s51, 45056
    s_mul_i32 s49, s48, 1536
    buffer_load_dwordx4 v200, s[8:11], s49 offen lds
    buffer_load_dwordx4 v201, s[8:11], s49 offen offset:1024 lds
    buffer_load_dwordx4 v202, s[8:11], s49 offen offset:2048 lds
    buffer_load_dwordx4 v203, s[8:11], s49 offen offset:3072 lds
    s_add_u32 m0, s51, 49152
    s_nop 0
    buffer_load_dwordx4 v204, s[8:11], s49 offen lds
    buffer_load_dwordx4 v205, s[8:11], s49 offen offset:1024 lds
    s_getreg_b32 s58, hwreg(HW_REG_XCC_ID, 0, 4)
    s_add_u32 s58, s58, 1
    s_and_b32 s57, s45, 3
    s_lshl_b32 s57, s57, 3
    s_lshl_b32 s58, s58, s57
    s_and_b32 s57, s45, 4
    s_lshl_b32 s59, s44, 3
    s_add_u32 s57, s57, s59
    v_mov_b32 v209, s58
    v_mov_b32 v208, s57
    s_waitcnt vmcnt(12) lgkmcnt(0)
    s_barrier
    ds_read_b128 a[32:35], v49 offset:0
    ds_read_b128 a[12:15], v45 offset:8192
    ds_read_b64_tr_b16 a[4:5], v55 offset:128
    ds_read_b64_tr_b16 a[6:7], v55 offset:1664
    ds_read_b128 a[16:19], v45 offset:0
    ds_read_b128 a[20:23], v45 offset:2048
    ds_read_b64_tr_b16 a[0:1], v55 offset:0
    ds_read_b64_tr_b16 a[2:3], v55 offset:1536
    ds_read_b128 a[24:27], v45 offset:4096
    ds_read_b128 a[28:31], v45 offset:6144
    ds_read_b64_tr_b16 a[8:9], v55 offset:256
    ds_read_b64_tr_b16 a[10:11], v55 offset:1792
    s_waitcnt lgkmcnt(0)
    v_mfma_f32_16x16x32_bf16 v[124:127], a[72:75], a[32:35], 0
    s_add_u32 m0, s50, 69632
    s_add_u32 s48, s53, 512
    s_and_b32 s48, s48, 0x3ff
    v_mfma_f32_16x16x32_bf16 v[128:131], a[32:35], a[32:35], 0
    buffer_load_dwordx4 v40, s[4:7], s48 offen lds
    v_mfma_f32_16x16x32_bf16 v[132:135], a[72:75], a[12:15], 0
    buffer_load_dwordx4 v41, s[4:7], s48 offen offset:1024 lds
    ds_read_b128 a[68:71], v51 offset:0
    v_mfma_f32_16x16x32_bf16 v[136:139], a[12:15], a[12:15], 0
    ds_read_b128 a[48:51], v47 offset:8192
    ds_read_b64_tr_b16 a[40:41], v55 offset:12416
    s_add_u32 m0, s56, 77824
    v_mfma_f32_16x16x32_bf16 v[64:67], a[4:7], a[12:15], 0
    s_mov_b64 exec, s[54:55]
    buffer_load_dwordx4 v42, s[4:7], s48 offen lds
    s_mov_b64 exec, -1
    v_mfma_f32_16x16x32_bf16 v[68:71], a[4:7], a[16:19], 0
    ds_read_b64_tr_b16 a[42:43], v55 offset:13952
    v_and_b32 v59, 2, v61
    ds_read_b128 a[52:55], v47 offset:0
    s_add_u32 m0, s51, 79872
    s_mul_i32 s49, s48, 1536
    v_mfma_f32_16x16x32_bf16 v[72:75], a[4:7], a[20:23], 0
    buffer_load_dwordx4 v200, s[8:11], s49 offen lds
    v_mfma_f32_16x16x32_bf16 v[76:79], a[4:7], a[24:27], 0
    v_xor_b32 v58, v62, v59
    ds_read_b128 a[56:59], v47 offset:2048
    v_mfma_f32_16x16x32_bf16 v[80:83], a[4:7], a[28:31], 0
    buffer_load_dwordx4 v201, s[8:11], s49 offen offset:1024 lds
    v_mfma_f32_16x16x32_bf16 v[84:87], a[0:3], a[12:15], 0
    ds_read_b64_tr_b16 a[36:37], v55 offset:12288
    v_lshlrev_b32 v58, 4, v58
    ds_read_b64_tr_b16 a[38:39], v55 offset:13824
    v_mfma_f32_16x16x32_bf16 v[88:91], a[0:3], a[16:19], 0
    buffer_load_dwordx4 v202, s[8:11], s49 offen offset:2048 lds
    v_mfma_f32_16x16x32_bf16 v[92:95], a[0:3], a[20:23], 0
    ds_read_b128 a[60:63], v47 offset:4096
    v_lshl_add_u32 v4, v61, 10, v58
    ds_read_b128 a[64:67], v47 offset:6144
    v_mfma_f32_16x16x32_bf16 v[96:99], a[0:3], a[24:27], 0
    buffer_load_dwordx4 v203, s[8:11], s49 offen offset:3072 lds
    v_mfma_f32_16x16x32_bf16 v[100:103], a[0:3], a[28:31], 0
    ds_read_b64_tr_b16 a[44:45], v55 offset:12544
    s_add_u32 m0, s51, 83968
    v_xor_b32 v58, 64, v4
    v_mfma_f32_16x16x32_bf16 v[104:107], a[12:15], a[8:11], 0
    buffer_load_dwordx4 v204, s[8:11], s49 offen lds
    v_mfma_f32_16x16x32_bf16 v[108:111], a[16:19], a[8:11], 0
    ds_read_b64_tr_b16 a[46:47], v55 offset:14080
    v_add_u32 v5, 7168, v58
    v_mfma_f32_16x16x32_bf16 v[112:115], a[20:23], a[8:11], 0
    buffer_load_dwordx4 v205, s[8:11], s49 offen offset:1024 lds
    v_mfma_f32_16x16x32_bf16 v[116:119], a[24:27], a[8:11], 0
    v_add_u32 v6, 14336, v4
    v_mfma_f32_16x16x32_bf16 v[120:123], a[28:31], a[8:11], 0
    v_add_u32 v7, 21504, v58
    s_lshl_b32 s64, s46, 13
    s_waitcnt vmcnt(9) lgkmcnt(0)
    s_barrier
    s_cmp_lg_u32 s46, 0
    s_cbranch_scc1 L_noann
    s_mov_b64 exec, 1
    buffer_atomic_or v209, v208, s[36:39], 0 offen
    s_mov_b64 exec, -1
L_noann:
    v_mfma_f32_16x16x32_bf16 v[124:127], a[72:75], a[68:71], v[124:127]
    s_add_u32 m0, s50, 104448
    s_add_u32 s48, s53, 768
    s_and_b32 s48, s48, 0x3ff
    v_mfma_f32_16x16x32_bf16 v[128:131], a[68:71], a[68:71], v[128:131]
    buffer_load_dwordx4 v40, s[4:7], s48 offen lds
    v_mfma_f32_16x16x32_bf16 v[132:135], a[72:75], a[48:51], v[132:135]
    ds_read_b128 a[32:35], v49 offset:34816
    ds_read_b128 a[12:15], v45 offset:43008
    v_mfma_f32_16x16x32_bf16 v[136:139], a[48:51], a[48:51], v[136:139]
    ds_read_b64_tr_b16 a[4:5], v55 offset:34944
    v_mfma_f32_16x16x32_bf16 v[64:67], a[40:43], a[48:51], v[64:67]
    ds_read_b64_tr_b16 a[6:7], v55 offset:36480
    v_mfma_f32_16x16x32_bf16 v[68:71], a[40:43], a[52:55], v[68:71]
    buffer_load_dwordx4 v41, s[4:7], s48 offen offset:1024 lds
    v_mfma_f32_16x16x32_bf16 v[72:75], a[40:43], a[56:59], v[72:75]
    ds_read_b128 a[16:19], v45 offset:34816
    s_lshl_b32 s41, s45, 7
    v_mfma_f32_16x16x32_bf16 v[76:79], a[40:43], a[60:63], v[76:79]
    ds_read_b128 a[20:23], v45 offset:36864
    s_lshl_b32 s65, s46, 16
    v_mfma_f32_16x16x32_bf16 v[80:83], a[40:43], a[64:67], v[80:83]
    ds_read_b64_tr_b16 a[0:1], v55 offset:34816
    s_add_u32 m0, s56, 112640
    v_mfma_f32_16x16x32_bf16 v[84:87], a[36:39], a[48:51], v[84:87]
    s_mov_b64 exec, s[54:55]
    buffer_load_dwordx4 v42, s[4:7], s48 offen lds
    s_mov_b64 exec, -1
    v_mfma_f32_16x16x32_bf16 v[88:91], a[36:39], a[52:55], v[88:91]
    ds_read_b64_tr_b16 a[2:3], v55 offset:36352
    s_add_u32 s65, s65, s41
    ds_read_b128 a[24:27], v45 offset:38912
    v_mfma_f32_16x16x32_bf16 v[92:95], a[36:39], a[56:59], v[92:95]
    ds_read_b128 a[28:31], v45 offset:40960
    s_add_u32 s67, s67, s41
    v_mfma_f32_16x16x32_bf16 v[96:99], a[36:39], a[60:63], v[96:99]
    ds_read_b64_tr_b16 a[8:9], v55 offset:35072
    s_add_u32 m0, s51, 114688
    s_mul_i32 s49, s48, 1536
    v_mfma_f32_16x16x32_bf16 v[100:103], a[36:39], a[64:67], v[100:103]
    buffer_load_dwordx4 v200, s[8:11], s49 offen lds
    v_mfma_f32_16x16x32_bf16 v[104:107], a[48:51], a[44:47], v[104:107]
    ds_read_b64_tr_b16 a[10:11], v55 offset:36608
    v_mov_b32 v58, 0x80000000
    v_mfma_f32_16x16x32_bf16 v[108:111], a[52:55], a[44:47], v[108:111]
    s_lshr_b32 s1, s2, 3
    v_mfma_f32_16x16x32_bf16 v[112:115], a[56:59], a[44:47], v[112:115]
    s_lshl_b32 s1, s1, 2
    s_add_u32 s1, s1, s46
    v_mfma_f32_16x16x32_bf16 v[116:119], a[60:63], a[44:47], v[116:119]
    buffer_load_dwordx4 v201, s[8:11], s49 offen offset:1024 lds
    v_mfma_f32_16x16x32_bf16 v[120:123], a[64:67], a[44:47], v[120:123]
    s_lshl_b32 s40, s1, 12
    v_lshl_add_u32 v210, v0, 7, s40
    s_waitcnt lgkmcnt(0)
    v_mfma_f32_16x16x32_bf16 v[124:127], a[72:75], a[32:35], v[124:127]
    ds_read_b128 a[68:71], v51 offset:34816
    v_cmp_gt_u32 vcc, 32, v0
    v_mfma_f32_16x16x32_bf16 v[128:131], a[32:35], a[32:35], v[128:131]
    ds_read_b128 a[48:51], v47 offset:43008
    v_mfma_f32_16x16x32_bf16 v[132:135], a[72:75], a[12:15], v[132:135]
    buffer_load_dwordx4 v202, s[8:11], s49 offen offset:2048 lds
    v_mfma_f32_16x16x32_bf16 v[136:139], a[12:15], a[12:15], v[136:139]
    ds_read_b64_tr_b16 a[40:41], v55 offset:47232
    ds_read_b64_tr_b16 a[42:43], v55 offset:48768
    v_mfma_f32_16x16x32_bf16 v[64:67], a[4:7], a[12:15], v[64:67]
    ds_read_b128 a[52:55], v47 offset:34816
    v_mfma_f32_16x16x32_bf16 v[68:71], a[4:7], a[16:19], v[68:71]
    ds_read_b128 a[56:59], v47 offset:36864
    ds_read_b64_tr_b16 a[36:37], v55 offset:47104
    v_mfma_f32_16x16x32_bf16 v[72:75], a[4:7], a[20:23], v[72:75]
    buffer_load_dwordx4 v203, s[8:11], s49 offen offset:3072 lds
    v_mfma_f32_16x16x32_bf16 v[76:79], a[4:7], a[24:27], v[76:79]
    ds_read_b64_tr_b16 a[38:39], v55 offset:48640
    v_mfma_f32_16x16x32_bf16 v[80:83], a[4:7], a[28:31], v[80:83]
    s_add_u32 m0, s51, 118784
    ds_read_b128 a[60:63], v47 offset:38912
    v_mfma_f32_16x16x32_bf16 v[84:87], a[0:3], a[12:15], v[84:87]
    v_cndmask_b32 v210, v58, v210, vcc
    v_mfma_f32_16x16x32_bf16 v[88:91], a[0:3], a[16:19], v[88:91]
    buffer_load_dwordx4 v204, s[8:11], s49 offen lds
    v_mfma_f32_16x16x32_bf16 v[92:95], a[0:3], a[20:23], v[92:95]
    ds_read_b128 a[64:67], v47 offset:40960
    ds_read_b64_tr_b16 a[44:45], v55 offset:47360
    v_mfma_f32_16x16x32_bf16 v[96:99], a[0:3], a[24:27], v[96:99]
    s_mul_i32 s40, s43, 1408
    v_mfma_f32_16x16x32_bf16 v[100:103], a[0:3], a[28:31], v[100:103]
    ds_read_b64_tr_b16 a[46:47], v55 offset:48896
    v_lshl_add_u32 v62, v0, 7, s40
    v_mfma_f32_16x16x32_bf16 v[104:107], a[12:15], a[8:11], v[104:107]
    buffer_load_dwordx4 v205, s[8:11], s49 offen offset:1024 lds
    v_mfma_f32_16x16x32_bf16 v[108:111], a[16:19], a[8:11], v[108:111]
    v_cmp_gt_u32 vcc, 11, v0
    s_nop 1
    v_cndmask_b32 v62, v58, v62, vcc
    v_mfma_f32_16x16x32_bf16 v[112:115], a[20:23], a[8:11], v[112:115]
    v_and_b32 v57, 31, v0
    v_lshlrev_b32 v30, 2, v57
    v_mfma_f32_16x16x32_bf16 v[116:119], a[24:27], a[8:11], v[116:119]
    v_lshlrev_b32 v57, 10, v2
    v_and_b32 v58, 1, v3
    v_mfma_f32_16x16x32_bf16 v[120:123], a[28:31], a[8:11], v[120:123]
    v_lshl_add_u32 v57, v58, 5, v57
    v_lshrrev_b32 v59, 1, v3
    s_waitcnt vmcnt(9) lgkmcnt(0)
    s_barrier
    v_mfma_f32_16x16x32_bf16 v[124:127], a[72:75], a[68:71], v[124:127]
    s_mov_b32 m0, s50
    s_add_u32 s48, s53, 1152
    s_and_b32 s48, s48, 0x3ff
    v_mfma_f32_16x16x32_bf16 v[128:131], a[68:71], a[68:71], v[128:131]
    buffer_load_dwordx4 v40, s[4:7], s48 offen lds
    v_mfma_f32_16x16x32_bf16 v[132:135], a[72:75], a[48:51], v[132:135]
    ds_read_b128 a[32:35], v50 offset:0
    ds_read_b128 a[12:15], v46 offset:8192
    v_mfma_f32_16x16x32_bf16 v[136:139], a[48:51], a[48:51], v[136:139]
    ds_read_b64_tr_b16 a[4:5], v56 offset:128
    v_mfma_f32_16x16x32_bf16 v[64:67], a[40:43], a[48:51], v[64:67]
    ds_read_b64_tr_b16 a[6:7], v56 offset:1664
    v_mfma_f32_16x16x32_bf16 v[68:71], a[40:43], a[52:55], v[68:71]
    buffer_load_dwordx4 v41, s[4:7], s48 offen offset:1024 lds
    v_mfma_f32_16x16x32_bf16 v[72:75], a[40:43], a[56:59], v[72:75]
    ds_read_b128 a[16:19], v46 offset:0
    v_mfma_f32_16x16x32_bf16 v[76:79], a[40:43], a[60:63], v[76:79]
    ds_read_b128 a[20:23], v46 offset:2048
    ds_read_b64_tr_b16 a[0:1], v56 offset:0
    v_mfma_f32_16x16x32_bf16 v[80:83], a[40:43], a[64:67], v[80:83]
    s_add_u32 m0, s56, 8192
    v_mfma_f32_16x16x32_bf16 v[84:87], a[36:39], a[48:51], v[84:87]
    s_mov_b64 exec, s[54:55]
    buffer_load_dwordx4 v42, s[4:7], s48 offen lds
    s_mov_b64 exec, -1
    v_mfma_f32_16x16x32_bf16 v[88:91], a[36:39], a[52:55], v[88:91]
    ds_read_b64_tr_b16 a[2:3], v56 offset:1536
    ds_read_b128 a[24:27], v46 offset:4096
    v_mfma_f32_16x16x32_bf16 v[92:95], a[36:39], a[56:59], v[92:95]
    ds_read_b128 a[28:31], v46 offset:6144
    v_mfma_f32_16x16x32_bf16 v[96:99], a[36:39], a[60:63], v[96:99]
    ds_read_b64_tr_b16 a[8:9], v56 offset:256
    s_add_u32 m0, s51, 10240
    s_mul_i32 s49, s48, 1536
    v_mfma_f32_16x16x32_bf16 v[100:103], a[36:39], a[64:67], v[100:103]
    buffer_load_dwordx4 v200, s[8:11], s49 offen lds
    v_mfma_f32_16x16x32_bf16 v[104:107], a[48:51], a[44:47], v[104:107]
    ds_read_b64_tr_b16 a[10:11], v56 offset:1792
    v_mfma_f32_16x16x32_bf16 v[108:111], a[52:55], a[44:47], v[108:111]
    v_lshl_add_u32 v31, v59, 4, v57
    v_mfma_f32_16x16x32_bf16 v[112:115], a[56:59], a[44:47], v[112:115]
    v_mov_b32 v63, 0xf149f2ca
    s_cmp_eq_u32 s44, 0
    s_cselect_b64 s[40:41], 0, -1
    v_mfma_f32_16x16x32_bf16 v[116:119], a[60:63], a[44:47], v[116:119]
    buffer_load_dwordx4 v201, s[8:11], s49 offen offset:1024 lds
    v_mfma_f32_16x16x32_bf16 v[120:123], a[64:67], a[44:47], v[120:123]
    v_cndmask_b32_e64 v240, v63, 0, s[68:69]
    s_waitcnt lgkmcnt(0)
    v_mfma_f32_16x16x32_bf16 v[124:127], a[72:75], a[32:35], v[124:127]
    ds_read_b128 a[68:71], v52 offset:0
    ds_read_b128 a[48:51], v48 offset:8192
    v_mfma_f32_16x16x32_bf16 v[128:131], a[32:35], a[32:35], v[128:131]
    ds_read_b64_tr_b16 a[40:41], v56 offset:12416
    v_mfma_f32_16x16x32_bf16 v[132:135], a[72:75], a[12:15], v[132:135]
    buffer_load_dwordx4 v202, s[8:11], s49 offen offset:2048 lds
    v_mfma_f32_16x16x32_bf16 v[136:139], a[12:15], a[12:15], v[136:139]
    ds_read_b64_tr_b16 a[42:43], v56 offset:13952
    ds_read_b128 a[52:55], v48 offset:0
    v_mfma_f32_16x16x32_bf16 v[64:67], a[4:7], a[12:15], v[64:67]
    v_cndmask_b32_e64 v244, v63, 0, s[76:77]
    v_mfma_f32_16x16x32_bf16 v[68:71], a[4:7], a[16:19], v[68:71]
    ds_read_b128 a[56:59], v48 offset:2048
    v_cndmask_b32_e64 v241, v63, 0, s[70:71]
    v_mfma_f32_16x16x32_bf16 v[72:75], a[4:7], a[20:23], v[72:75]
    buffer_load_dwordx4 v203, s[8:11], s49 offen offset:3072 lds
    v_mfma_f32_16x16x32_bf16 v[76:79], a[4:7], a[24:27], v[76:79]
    ds_read_b64_tr_b16 a[36:37], v56 offset:12288
    v_mfma_f32_16x16x32_bf16 v[80:83], a[4:7], a[28:31], v[80:83]
    ds_read_b64_tr_b16 a[38:39], v56 offset:13824
    s_add_u32 m0, s51, 14336
    v_mfma_f32_16x16x32_bf16 v[84:87], a[0:3], a[12:15], v[84:87]
    ds_read_b128 a[60:63], v48 offset:4096
    v_mfma_f32_16x16x32_bf16 v[88:91], a[0:3], a[16:19], v[88:91]
    buffer_load_dwordx4 v204, s[8:11], s49 offen lds
    v_mfma_f32_16x16x32_bf16 v[92:95], a[0:3], a[20:23], v[92:95]
    v_cndmask_b32_e64 v245, v63, 0, s[78:79]
    ds_read_b128 a[64:67], v48 offset:6144
    v_mfma_f32_16x16x32_bf16 v[96:99], a[0:3], a[24:27], v[96:99]
    ds_read_b64_tr_b16 a[44:45], v56 offset:12544
    v_cndmask_b32_e64 v242, v63, 0, s[72:73]
    v_mfma_f32_16x16x32_bf16 v[100:103], a[0:3], a[28:31], v[100:103]
    ds_read_b64_tr_b16 a[46:47], v56 offset:14080
    v_mfma_f32_16x16x32_bf16 v[104:107], a[12:15], a[8:11], v[104:107]
    buffer_load_dwordx4 v205, s[8:11], s49 offen offset:1024 lds
    v_mfma_f32_16x16x32_bf16 v[108:111], a[16:19], a[8:11], v[108:111]
    v_cndmask_b32_e64 v246, v63, 0, s[80:81]
    v_mfma_f32_16x16x32_bf16 v[112:115], a[20:23], a[8:11], v[112:115]
    v_cndmask_b32_e64 v243, v63, 0, s[74:75]
    v_mfma_f32_16x16x32_bf16 v[116:119], a[24:27], a[8:11], v[116:119]
    v_cndmask_b32_e64 v247, v63, 0, s[82:83]
    v_cndmask_b32_e64 v248, v63, v244, s[40:41]
    v_mfma_f32_16x16x32_bf16 v[120:123], a[28:31], a[8:11], v[120:123]
    v_cndmask_b32_e64 v249, v63, v245, s[40:41]
    s_waitcnt vmcnt(9) lgkmcnt(0)
    s_barrier
    v_mfma_f32_16x16x32_bf16 v[124:127], a[72:75], a[68:71], v[124:127]
    s_add_u32 m0, s50, 34816
    s_add_u32 s48, s53, 1408
    s_and_b32 s48, s48, 0x3ff
    v_mfma_f32_16x16x32_bf16 v[128:131], a[68:71], a[68:71], v[128:131]
    buffer_load_dwordx4 v40, s[4:7], s48 offen lds
    v_mfma_f32_16x16x32_bf16 v[132:135], a[72:75], a[48:51], v[132:135]
    ds_read_b128 a[32:35], v50 offset:34816
    ds_read_b128 a[12:15], v46 offset:43008
    v_mfma_f32_16x16x32_bf16 v[136:139], a[48:51], a[48:51], v[136:139]
    ds_read_b64_tr_b16 a[4:5], v56 offset:34944
    v_mfma_f32_16x16x32_bf16 v[64:67], a[40:43], a[48:51], v[64:67]
    ds_read_b64_tr_b16 a[6:7], v56 offset:36480
    v_mfma_f32_16x16x32_bf16 v[68:71], a[40:43], a[52:55], v[68:71]
    buffer_load_dwordx4 v41, s[4:7], s48 offen offset:1024 lds
    v_mfma_f32_16x16x32_bf16 v[72:75], a[40:43], a[56:59], v[72:75]
    ds_read_b128 a[16:19], v46 offset:34816
    v_cndmask_b32_e64 v250, v63, v246, s[40:41]
    v_mfma_f32_16x16x32_bf16 v[76:79], a[40:43], a[60:63], v[76:79]
    ds_read_b128 a[20:23], v46 offset:36864
    v_mfma_f32_16x16x32_bf16 v[80:83], a[40:43], a[64:67], v[80:83]
    ds_read_b64_tr_b16 a[0:1], v56 offset:34816
    s_add_u32 m0, s56, 43008
    v_cndmask_b32_e64 v251, v63, v247, s[40:41]
    v_mfma_f32_16x16x32_bf16 v[84:87], a[36:39], a[48:51], v[84:87]
    s_mov_b64 exec, s[54:55]
    buffer_load_dwordx4 v42, s[4:7], s48 offen lds
    s_mov_b64 exec, -1
    v_mfma_f32_16x16x32_bf16 v[88:91], a[36:39], a[52:55], v[88:91]
    ds_read_b64_tr_b16 a[2:3], v56 offset:36352
    ds_read_b128 a[24:27], v46 offset:38912
    v_mfma_f32_16x16x32_bf16 v[92:95], a[36:39], a[56:59], v[92:95]
    ds_read_b128 a[28:31], v46 offset:40960
    v_lshlrev_b32 v58, 2, v2
    v_mfma_f32_16x16x32_bf16 v[96:99], a[36:39], a[60:63], v[96:99]
    ds_read_b64_tr_b16 a[8:9], v56 offset:35072
    s_add_u32 m0, s51, 45056
    s_mul_i32 s49, s48, 1536
    v_mfma_f32_16x16x32_bf16 v[100:103], a[36:39], a[64:67], v[100:103]
    buffer_load_dwordx4 v200, s[8:11], s49 offen lds
    v_mfma_f32_16x16x32_bf16 v[104:107], a[48:51], a[44:47], v[104:107]
    v_mov_b32 v59, 3072
    ds_read_b64_tr_b16 a[10:11], v56 offset:36608
    v_mfma_f32_16x16x32_bf16 v[108:111], a[52:55], a[44:47], v[108:111]
    v_cndmask_b32_e64 v59, v59, v58, s[90:91]
    v_mfma_f32_16x16x32_bf16 v[112:115], a[56:59], a[44:47], v[112:115]
    v_add_u32 v252, 155648, v59
    v_mfma_f32_16x16x32_bf16 v[116:119], a[60:63], a[44:47], v[116:119]
    buffer_load_dwordx4 v201, s[8:11], s49 offen offset:1024 lds
    v_mfma_f32_16x16x32_bf16 v[120:123], a[64:67], a[44:47], v[120:123]
    s_lshl_b32 s40, s46, 6
    s_add_u32 s41, s40, 64
    s_waitcnt lgkmcnt(0)
    v_mfma_f32_16x16x32_bf16 v[124:127], a[72:75], a[32:35], v[124:127]
    ds_read_b128 a[68:71], v52 offset:34816
    ds_read_b128 a[48:51], v48 offset:43008
    v_mfma_f32_16x16x32_bf16 v[128:131], a[32:35], a[32:35], v[128:131]
    ds_read_b64_tr_b16 a[40:41], v56 offset:47232
    v_mfma_f32_16x16x32_bf16 v[132:135], a[72:75], a[12:15], v[132:135]
    buffer_load_dwordx4 v202, s[8:11], s49 offen offset:2048 lds
    v_mfma_f32_16x16x32_bf16 v[136:139], a[12:15], a[12:15], v[136:139]
    ds_read_b64_tr_b16 a[42:43], v56 offset:48768
    ds_read_b128 a[52:55], v48 offset:34816
    v_mfma_f32_16x16x32_bf16 v[64:67], a[4:7], a[12:15], v[64:67]
    v_add_u32 v253, s41, v252
    v_mfma_f32_16x16x32_bf16 v[68:71], a[4:7], a[16:19], v[68:71]
    ds_read_b128 a[56:59], v48 offset:36864
    s_add_u32 s40, s40, 157696
    v_mfma_f32_16x16x32_bf16 v[72:75], a[4:7], a[20:23], v[72:75]
    buffer_load_dwordx4 v203, s[8:11], s49 offen offset:3072 lds
    v_mfma_f32_16x16x32_bf16 v[76:79], a[4:7], a[24:27], v[76:79]
    ds_read_b64_tr_b16 a[36:37], v56 offset:47104
    v_add_u32 v255, s40, v58
    v_mfma_f32_16x16x32_bf16 v[80:83], a[4:7], a[28:31], v[80:83]
    ds_read_b64_tr_b16 a[38:39], v56 offset:48640
    v_mfma_f32_16x16x32_bf16 v[84:87], a[0:3], a[12:15], v[84:87]
    s_add_u32 m0, s51, 49152
    ds_read_b128 a[60:63], v48 offset:38912
    v_mfma_f32_16x16x32_bf16 v[88:91], a[0:3], a[16:19], v[88:91]
    buffer_load_dwordx4 v204, s[8:11], s49 offen lds
    v_mfma_f32_16x16x32_bf16 v[92:95], a[0:3], a[20:23], v[92:95]
    ds_read_b128 a[64:67], v48 offset:40960
    v_mfma_f32_16x16x32_bf16 v[96:99], a[0:3], a[24:27], v[96:99]
    ds_read_b64_tr_b16 a[44:45], v56 offset:47360
    v_mov_b32 v57, 158720
    v_mfma_f32_16x16x32_bf16 v[100:103], a[0:3], a[28:31], v[100:103]
    ds_read_b64_tr_b16 a[46:47], v56 offset:48896
    v_mfma_f32_16x16x32_bf16 v[104:107], a[12:15], a[8:11], v[104:107]
    buffer_load_dwordx4 v205, s[8:11], s49 offen offset:1024 lds
    v_mfma_f32_16x16x32_bf16 v[108:111], a[16:19], a[8:11], v[108:111]
    v_cndmask_b32_e64 v254, v57, v255, s[92:93]
    v_mul_u32_u24 v57, 2979, v0
    v_mfma_f32_16x16x32_bf16 v[112:115], a[20:23], a[8:11], v[112:115]
    v_lshlrev_b32 v58, 4, v0
    v_mfma_f32_16x16x32_bf16 v[116:119], a[24:27], a[8:11], v[116:119]
    v_add_u32 v59, 4096, v58
    v_add_u32 v60, 8192, v58
    v_mfma_f32_16x16x32_bf16 v[120:123], a[28:31], a[8:11], v[120:123]
    s_movk_i32 s40, 2400
    v_mov_b32 v63, v57
    s_waitcnt vmcnt(9) lgkmcnt(0)
    s_barrier
    v_mfma_f32_16x16x32_bf16 v[124:127], a[72:75], a[68:71], v[124:127]
    s_add_u32 m0, s50, 69632
    s_add_u32 s48, s53, 1664
    s_and_b32 s48, s48, 0x3ff
    v_mfma_f32_16x16x32_bf16 v[128:131], a[68:71], a[68:71], v[128:131]
    buffer_load_dwordx4 v40, s[4:7], s48 offen lds
    v_mfma_f32_16x16x32_bf16 v[132:135], a[72:75], a[48:51], v[132:135]
    ds_read_b128 a[32:35], v49 offset:0
    ds_read_b128 a[12:15], v45 offset:8192
    v_mfma_f32_16x16x32_bf16 v[136:139], a[48:51], a[48:51], v[136:139]
    ds_read_b64_tr_b16 a[4:5], v55 offset:128
    v_mfma_f32_16x16x32_bf16 v[64:67], a[40:43], a[48:51], v[64:67]
    ds_read_b64_tr_b16 a[6:7], v55 offset:1664
    v_mfma_f32_16x16x32_bf16 v[68:71], a[40:43], a[52:55], v[68:71]
    buffer_load_dwordx4 v41, s[4:7], s48 offen offset:1024 lds
    v_mfma_f32_16x16x32_bf16 v[72:75], a[40:43], a[56:59], v[72:75]
    ds_read_b128 a[16:19], v45 offset:0
    v_lshrrev_b32 v63, 16, v63
    v_mfma_f32_16x16x32_bf16 v[76:79], a[40:43], a[60:63], v[76:79]
    ds_read_b128 a[20:23], v45 offset:2048
    v_mfma_f32_16x16x32_bf16 v[80:83], a[40:43], a[64:67], v[80:83]
    ds_read_b64_tr_b16 a[0:1], v55 offset:0
    s_add_u32 m0, s56, 77824
    v_mfma_f32_16x16x32_bf16 v[84:87], a[36:39], a[48:51], v[84:87]
    s_mov_b64 exec, s[54:55]
    buffer_load_dwordx4 v42, s[4:7], s48 offen lds
    s_mov_b64 exec, -1
    v_mfma_f32_16x16x32_bf16 v[88:91], a[36:39], a[52:55], v[88:91]
    ds_read_b64_tr_b16 a[2:3], v55 offset:1536
    ds_read_b128 a[24:27], v45 offset:4096
    v_mfma_f32_16x16x32_bf16 v[92:95], a[36:39], a[56:59], v[92:95]
    ds_read_b128 a[28:31], v45 offset:6144
    v_mfma_f32_16x16x32_bf16 v[96:99], a[36:39], a[60:63], v[96:99]
    ds_read_b64_tr_b16 a[8:9], v55 offset:256
    s_add_u32 m0, s51, 79872
    s_mul_i32 s49, s48, 1536
    v_mad_u32_u24 v8, v63, s40, v58
    v_mfma_f32_16x16x32_bf16 v[100:103], a[36:39], a[64:67], v[100:103]
    buffer_load_dwordx4 v200, s[8:11], s49 offen lds
    v_mfma_f32_16x16x32_bf16 v[104:107], a[48:51], a[44:47], v[104:107]
    ds_read_b64_tr_b16 a[10:11], v55 offset:1792
    v_mfma_f32_16x16x32_bf16 v[108:111], a[52:55], a[44:47], v[108:111]
    v_add_u32 v63, 190656, v57
    v_lshrrev_b32 v63, 16, v63
    v_mfma_f32_16x16x32_bf16 v[112:115], a[56:59], a[44:47], v[112:115]
    v_mad_u32_u24 v9, v63, s40, v58
    v_mfma_f32_16x16x32_bf16 v[116:119], a[60:63], a[44:47], v[116:119]
    buffer_load_dwordx4 v201, s[8:11], s49 offen offset:1024 lds
    v_mfma_f32_16x16x32_bf16 v[120:123], a[64:67], a[44:47], v[120:123]
    v_add_u32 v63, 381312, v57
    v_lshrrev_b32 v63, 16, v63
    s_waitcnt lgkmcnt(0)
    v_mfma_f32_16x16x32_bf16 v[124:127], a[72:75], a[32:35], v[124:127]
    ds_read_b128 a[68:71], v51 offset:0
    ds_read_b128 a[48:51], v47 offset:8192
    v_mfma_f32_16x16x32_bf16 v[128:131], a[32:35], a[32:35], v[128:131]
    ds_read_b64_tr_b16 a[40:41], v55 offset:12416
    v_mfma_f32_16x16x32_bf16 v[132:135], a[72:75], a[12:15], v[132:135]
    buffer_load_dwordx4 v202, s[8:11], s49 offen offset:2048 lds
    v_mfma_f32_16x16x32_bf16 v[136:139], a[12:15], a[12:15], v[136:139]
    ds_read_b64_tr_b16 a[42:43], v55 offset:13952
    ds_read_b128 a[52:55], v47 offset:0
    v_mfma_f32_16x16x32_bf16 v[64:67], a[4:7], a[12:15], v[64:67]
    ds_read_b128 a[56:59], v47 offset:2048
    v_mfma_f32_16x16x32_bf16 v[68:71], a[4:7], a[16:19], v[68:71]
    v_mad_u32_u24 v10, v63, s40, v58
    ds_read_b64_tr_b16 a[36:37], v55 offset:12288
    v_mfma_f32_16x16x32_bf16 v[72:75], a[4:7], a[20:23], v[72:75]
    buffer_load_dwordx4 v203, s[8:11], s49 offen offset:3072 lds
    v_mfma_f32_16x16x32_bf16 v[76:79], a[4:7], a[24:27], v[76:79]
    ds_read_b64_tr_b16 a[38:39], v55 offset:13824
    v_mfma_f32_16x16x32_bf16 v[80:83], a[4:7], a[28:31], v[80:83]
    s_add_u32 m0, s51, 83968
    v_add_u32 v63, 571968, v57
    v_mfma_f32_16x16x32_bf16 v[84:87], a[0:3], a[12:15], v[84:87]
    ds_read_b128 a[60:63], v47 offset:4096
    v_mfma_f32_16x16x32_bf16 v[88:91], a[0:3], a[16:19], v[88:91]
    buffer_load_dwordx4 v204, s[8:11], s49 offen lds
    v_mfma_f32_16x16x32_bf16 v[92:95], a[0:3], a[20:23], v[92:95]
    ds_read_b128 a[64:67], v47 offset:6144
    v_lshrrev_b32 v63, 16, v63
    v_mfma_f32_16x16x32_bf16 v[96:99], a[0:3], a[24:27], v[96:99]
    ds_read_b64_tr_b16 a[44:45], v55 offset:12544
    v_mfma_f32_16x16x32_bf16 v[100:103], a[0:3], a[28:31], v[100:103]
    v_mad_u32_u24 v11, v63, s40, v58
    ds_read_b64_tr_b16 a[46:47], v55 offset:14080
    v_mfma_f32_16x16x32_bf16 v[104:107], a[12:15], a[8:11], v[104:107]
    buffer_load_dwordx4 v205, s[8:11], s49 offen offset:1024 lds
    v_mfma_f32_16x16x32_bf16 v[108:111], a[16:19], a[8:11], v[108:111]
    v_add_u32 v63, 762624, v57
    v_lshrrev_b32 v63, 16, v63
    v_mfma_f32_16x16x32_bf16 v[112:115], a[20:23], a[8:11], v[112:115]
    v_mad_u32_u24 v12, v63, s40, v59
    v_mfma_f32_16x16x32_bf16 v[116:119], a[24:27], a[8:11], v[116:119]
    v_add_u32 v63, 953280, v57
    v_lshrrev_b32 v63, 16, v63
    v_mfma_f32_16x16x32_bf16 v[120:123], a[28:31], a[8:11], v[120:123]
    v_mad_u32_u24 v13, v63, s40, v59
    s_waitcnt vmcnt(9) lgkmcnt(0)
    s_barrier
    v_mfma_f32_16x16x32_bf16 v[124:127], a[72:75], a[68:71], v[124:127]
    s_add_u32 m0, s50, 104448
    s_add_u32 s48, s53, 1920
    s_and_b32 s48, s48, 0x3ff
    v_mfma_f32_16x16x32_bf16 v[128:131], a[68:71], a[68:71], v[128:131]
    buffer_load_dwordx4 v40, s[4:7], s48 offen lds
    v_mfma_f32_16x16x32_bf16 v[132:135], a[72:75], a[48:51], v[132:135]
    ds_read_b128 a[32:35], v49 offset:34816
    ds_read_b128 a[12:15], v45 offset:43008
    v_mfma_f32_16x16x32_bf16 v[136:139], a[48:51], a[48:51], v[136:139]
    ds_read_b64_tr_b16 a[4:5], v55 offset:34944
    v_mfma_f32_16x16x32_bf16 v[64:67], a[40:43], a[48:51], v[64:67]
    buffer_load_dwordx4 v41, s[4:7], s48 offen offset:1024 lds
    v_mfma_f32_16x16x32_bf16 v[68:71], a[40:43], a[52:55], v[68:71]
    ds_read_b64_tr_b16 a[6:7], v55 offset:36480
    ds_read_b128 a[16:19], v45 offset:34816
    v_mfma_f32_16x16x32_bf16 v[72:75], a[40:43], a[56:59], v[72:75]
    s_add_u32 m0, s56, 112640
    v_mfma_f32_16x16x32_bf16 v[76:79], a[40:43], a[60:63], v[76:79]
    s_mov_b64 exec, s[54:55]
    buffer_load_dwordx4 v42, s[4:7], s48 offen lds
    s_mov_b64 exec, -1
    v_mfma_f32_16x16x32_bf16 v[80:83], a[40:43], a[64:67], v[80:83]
    ds_read_b128 a[20:23], v45 offset:36864
    ds_read_b64_tr_b16 a[0:1], v55 offset:34816
    v_mfma_f32_16x16x32_bf16 v[84:87], a[36:39], a[48:51], v[84:87]
    ds_read_b64_tr_b16 a[2:3], v55 offset:36352
    s_add_u32 m0, s51, 114688
    s_mul_i32 s49, s48, 1536
    v_mfma_f32_16x16x32_bf16 v[88:91], a[36:39], a[52:55], v[88:91]
    buffer_load_dwordx4 v200, s[8:11], s49 offen lds
    v_mfma_f32_16x16x32_bf16 v[92:95], a[36:39], a[56:59], v[92:95]
    ds_read_b128 a[24:27], v45 offset:38912
    v_add_u32 v63, 1143936, v57
    ds_read_b128 a[28:31], v45 offset:40960
    v_mfma_f32_16x16x32_bf16 v[96:99], a[36:39], a[60:63], v[96:99]
    ds_read_b64_tr_b16 a[8:9], v55 offset:35072
    v_lshrrev_b32 v63, 16, v63
    v_mfma_f32_16x16x32_bf16 v[100:103], a[36:39], a[64:67], v[100:103]
    buffer_load_dwordx4 v201, s[8:11], s49 offen offset:1024 lds
    v_mfma_f32_16x16x32_bf16 v[104:107], a[48:51], a[44:47], v[104:107]
    ds_read_b64_tr_b16 a[10:11], v55 offset:36608
    v_mad_u32_u24 v14, v63, s40, v59
    v_mfma_f32_16x16x32_bf16 v[108:111], a[52:55], a[44:47], v[108:111]
    v_add_u32 v63, 1334592, v57
    v_mfma_f32_16x16x32_bf16 v[112:115], a[56:59], a[44:47], v[112:115]
    buffer_load_dwordx4 v202, s[8:11], s49 offen offset:2048 lds
    v_mfma_f32_16x16x32_bf16 v[116:119], a[60:63], a[44:47], v[116:119]
    v_lshrrev_b32 v63, 16, v63
    v_mfma_f32_16x16x32_bf16 v[120:123], a[64:67], a[44:47], v[120:123]
    v_mad_u32_u24 v15, v63, s40, v59
    v_add_u32 v63, 1525248, v57
    s_waitcnt lgkmcnt(0)
    v_mfma_f32_16x16x32_bf16 v[124:127], a[72:75], a[32:35], v[124:127]
    buffer_load_dwordx4 v203, s[8:11], s49 offen offset:3072 lds
    v_mfma_f32_16x16x32_bf16 v[128:131], a[32:35], a[32:35], v[128:131]
    ds_read_b128 a[68:71], v51 offset:34816
    v_lshrrev_b32 v63, 16, v63
    v_mfma_f32_16x16x32_bf16 v[132:135], a[72:75], a[12:15], v[132:135]
    ds_read_b128 a[48:51], v47 offset:43008
    s_add_u32 m0, s51, 118784
    v_mfma_f32_16x16x32_bf16 v[136:139], a[12:15], a[12:15], v[136:139]
    buffer_load_dwordx4 v204, s[8:11], s49 offen lds
    v_mfma_f32_16x16x32_bf16 v[64:67], a[4:7], a[12:15], v[64:67]
    ds_read_b64_tr_b16 a[40:41], v55 offset:47232
    ds_read_b64_tr_b16 a[42:43], v55 offset:48768
    v_mfma_f32_16x16x32_bf16 v[68:71], a[4:7], a[16:19], v[68:71]
    ds_read_b128 a[52:55], v47 offset:34816
    v_mfma_f32_16x16x32_bf16 v[72:75], a[4:7], a[20:23], v[72:75]
    buffer_load_dwordx4 v205, s[8:11], s49 offen offset:1024 lds
    v_mfma_f32_16x16x32_bf16 v[76:79], a[4:7], a[24:27], v[76:79]
    ds_read_b128 a[56:59], v47 offset:36864
    v_mfma_f32_16x16x32_bf16 v[80:83], a[4:7], a[28:31], v[80:83]
    ds_read_b64_tr_b16 a[36:37], v55 offset:47104
    v_mfma_f32_16x16x32_bf16 v[84:87], a[0:3], a[12:15], v[84:87]
    buffer_load_dword v238, v210, s[12:15], 0 offen sc1
    v_mfma_f32_16x16x32_bf16 v[88:91], a[0:3], a[16:19], v[88:91]
    ds_read_b64_tr_b16 a[38:39], v55 offset:48640
    v_mad_u32_u24 v16, v63, s40, v60
    ds_read_b128 a[60:63], v47 offset:38912
    v_mfma_f32_16x16x32_bf16 v[92:95], a[0:3], a[20:23], v[92:95]
    ds_read_b128 a[64:67], v47 offset:40960
    v_add_u32 v63, 1715904, v57
    v_mfma_f32_16x16x32_bf16 v[96:99], a[0:3], a[24:27], v[96:99]
    buffer_load_dword v238, v62, s[16:19], 0 offen
    v_mfma_f32_16x16x32_bf16 v[100:103], a[0:3], a[28:31], v[100:103]
    ds_read_b64_tr_b16 a[44:45], v55 offset:47360
    v_lshrrev_b32 v63, 16, v63
    v_mfma_f32_16x16x32_bf16 v[104:107], a[12:15], a[8:11], v[104:107]
    ds_read_b64_tr_b16 a[46:47], v55 offset:48896
    v_mfma_f32_16x16x32_bf16 v[108:111], a[16:19], a[8:11], v[108:111]
    buffer_load_dword v238, v62, s[20:23], 0 offen
    v_mfma_f32_16x16x32_bf16 v[112:115], a[20:23], a[8:11], v[112:115]
    v_mad_u32_u24 v17, v63, s40, v60
    v_mfma_f32_16x16x32_bf16 v[116:119], a[24:27], a[8:11], v[116:119]
    v_add_u32 v63, 1906560, v57
    v_lshrrev_b32 v63, 16, v63
    v_mfma_f32_16x16x32_bf16 v[120:123], a[28:31], a[8:11], v[120:123]
    v_mad_u32_u24 v18, v63, s40, v60
    s_mul_i32 s42, s45, 11
    s_waitcnt vmcnt(12) lgkmcnt(0)
    s_barrier
    v_mfma_f32_16x16x32_bf16 v[124:127], a[72:75], a[68:71], v[124:127]
    ds_read_b128 a[32:35], v50 offset:0
    s_min_u32 s42, s42, 75
    v_mfma_f32_16x16x32_bf16 v[128:131], a[68:71], a[68:71], v[128:131]
    ds_read_b128 a[12:15], v46 offset:8192
    s_lshl_b32 s41, s42, 5
    v_mfma_f32_16x16x32_bf16 v[132:135], a[72:75], a[48:51], v[132:135]
    ds_read_b64_tr_b16 a[4:5], v56 offset:128
    v_mfma_f32_16x16x32_bf16 v[136:139], a[48:51], a[48:51], v[136:139]
    ds_read_b64_tr_b16 a[6:7], v56 offset:1664
    ds_read_b128 a[16:19], v46 offset:0
    v_mfma_f32_16x16x32_bf16 v[64:67], a[40:43], a[48:51], v[64:67]
    ds_read_b128 a[20:23], v46 offset:2048
    v_mfma_f32_16x16x32_bf16 v[68:71], a[40:43], a[52:55], v[68:71]
    ds_read_b64_tr_b16 a[0:1], v56 offset:0
    ds_read_b64_tr_b16 a[2:3], v56 offset:1536
    v_mfma_f32_16x16x32_bf16 v[72:75], a[40:43], a[56:59], v[72:75]
    ds_read_b128 a[24:27], v46 offset:4096
    v_mfma_f32_16x16x32_bf16 v[76:79], a[40:43], a[60:63], v[76:79]
    ds_read_b128 a[28:31], v46 offset:6144
    ds_read_b64_tr_b16 a[8:9], v56 offset:256
    v_mfma_f32_16x16x32_bf16 v[80:83], a[40:43], a[64:67], v[80:83]
    s_mul_i32 s63, s46, 88064
    v_mfma_f32_16x16x32_bf16 v[84:87], a[36:39], a[48:51], v[84:87]
    ds_read_b64_tr_b16 a[10:11], v56 offset:1792
    s_add_u32 s63, s63, s41
    v_mfma_f32_16x16x32_bf16 v[88:91], a[36:39], a[52:55], v[88:91]
    s_bfe_u32 s40, s44, 65537
    v_mfma_f32_16x16x32_bf16 v[92:95], a[36:39], a[56:59], v[92:95]
    s_mul_i32 s41, s40, 352256
    s_add_u32 s63, s63, s41
    v_mfma_f32_16x16x32_bf16 v[96:99], a[36:39], a[60:63], v[96:99]
    s_lshl_b32 s41, s41, 1
    s_sub_u32 s3, 352256, s41
    v_mfma_f32_16x16x32_bf16 v[100:103], a[36:39], a[64:67], v[100:103]
    s_mul_i32 s62, s46, 11264
    v_mfma_f32_16x16x32_bf16 v[104:107], a[48:51], a[44:47], v[104:107]
    s_add_u32 s62, s62, 65536
    v_lshrrev_b32 v57, 2, v2
    v_mfma_f32_16x16x32_bf16 v[108:111], a[52:55], a[44:47], v[108:111]
    v_lshl_add_u32 v57, v3, 2, v57
    v_mul_u32_u24 v57, 352, v57
    v_mfma_f32_16x16x32_bf16 v[112:115], a[56:59], a[44:47], v[112:115]
    v_and_b32 v58, 3, v2
    v_lshl_add_u32 v57, v58, 3, v57
    v_mfma_f32_16x16x32_bf16 v[116:119], a[60:63], a[44:47], v[116:119]
    s_mul_i32 s41, s46, 96
    v_mfma_f32_16x16x32_bf16 v[120:123], a[64:67], a[44:47], v[120:123]
    s_add_u32 s41, s41, 65536
    v_add_u32 v23, s41, v57
    s_waitcnt lgkmcnt(0)
    v_mfma_f32_16x16x32_bf16 v[124:127], a[72:75], a[32:35], v[124:127]
    ds_read_b128 a[68:71], v52 offset:0
    ds_read_b128 a[48:51], v48 offset:8192
    v_mfma_f32_16x16x32_bf16 v[128:131], a[32:35], a[32:35], v[128:131]
    ds_read_b64_tr_b16 a[40:41], v56 offset:12416
    v_mfma_f32_16x16x32_bf16 v[132:135], a[72:75], a[12:15], v[132:135]
    ds_read_b64_tr_b16 a[42:43], v56 offset:13952
    ds_read_b128 a[52:55], v48 offset:0
    v_mfma_f32_16x16x32_bf16 v[136:139], a[12:15], a[12:15], v[136:139]
    ds_read_b128 a[56:59], v48 offset:2048
    v_mfma_f32_16x16x32_bf16 v[64:67], a[4:7], a[12:15], v[64:67]
    ds_read_b64_tr_b16 a[36:37], v56 offset:12288
    ds_read_b64_tr_b16 a[38:39], v56 offset:13824
    v_mfma_f32_16x16x32_bf16 v[68:71], a[4:7], a[16:19], v[68:71]
    ds_read_b128 a[60:63], v48 offset:4096
    v_mfma_f32_16x16x32_bf16 v[72:75], a[4:7], a[20:23], v[72:75]
    ds_read_b128 a[64:67], v48 offset:6144
    ds_read_b64_tr_b16 a[44:45], v56 offset:12544
    v_mfma_f32_16x16x32_bf16 v[76:79], a[4:7], a[24:27], v[76:79]
    ds_read_b64_tr_b16 a[46:47], v56 offset:14080
    v_mfma_f32_16x16x32_bf16 v[80:83], a[4:7], a[28:31], v[80:83]
    v_add_u32 v24, 45056, v23
    v_and_b32 v58, 1, v3
    v_mfma_f32_16x16x32_bf16 v[84:87], a[0:3], a[12:15], v[84:87]
    v_lshrrev_b32 v59, 1, v3
    v_lshlrev_b32 v57, 4, v2
    v_mfma_f32_16x16x32_bf16 v[88:91], a[0:3], a[16:19], v[88:91]
    v_lshl_add_u32 v57, v59, 8, v57
    v_lshl_add_u32 v61, v58, 10, v57
    v_mfma_f32_16x16x32_bf16 v[92:95], a[0:3], a[20:23], v[92:95]
    v_lshl_add_u32 v26, v58, 14, v57
    v_mfma_f32_16x16x32_bf16 v[96:99], a[0:3], a[24:27], v[96:99]
    s_lshl_b32 s40, s45, 11
    s_lshl_b32 s41, s46, 9
    s_add_u32 s66, s40, s41
    v_mfma_f32_16x16x32_bf16 v[100:103], a[0:3], a[28:31], v[100:103]
    s_add_u32 s66, s66, 65536
    v_mfma_f32_16x16x32_bf16 v[104:107], a[12:15], a[8:11], v[104:107]
    v_mfma_f32_16x16x32_bf16 v[108:111], a[16:19], a[8:11], v[108:111]
    v_mfma_f32_16x16x32_bf16 v[112:115], a[20:23], a[8:11], v[112:115]
    v_mfma_f32_16x16x32_bf16 v[116:119], a[24:27], a[8:11], v[116:119]
    v_mfma_f32_16x16x32_bf16 v[120:123], a[28:31], a[8:11], v[120:123]
    s_waitcnt vmcnt(3) lgkmcnt(0)
    s_barrier
    v_mfma_f32_16x16x32_bf16 v[124:127], a[72:75], a[68:71], v[124:127]
    ds_read_b128 a[32:35], v50 offset:34816
    ds_read_b128 a[12:15], v46 offset:43008
    v_mfma_f32_16x16x32_bf16 v[128:131], a[68:71], a[68:71], v[128:131]
    ds_read_b64_tr_b16 a[4:5], v56 offset:34944
    v_mfma_f32_16x16x32_bf16 v[132:135], a[72:75], a[48:51], v[132:135]
    ds_read_b64_tr_b16 a[6:7], v56 offset:36480
    ds_read_b128 a[16:19], v46 offset:34816
    v_mfma_f32_16x16x32_bf16 v[136:139], a[48:51], a[48:51], v[136:139]
    ds_read_b128 a[20:23], v46 offset:36864
    v_mfma_f32_16x16x32_bf16 v[64:67], a[40:43], a[48:51], v[64:67]
    ds_read_b64_tr_b16 a[0:1], v56 offset:34816
    ds_read_b64_tr_b16 a[2:3], v56 offset:36352
    v_mfma_f32_16x16x32_bf16 v[68:71], a[40:43], a[52:55], v[68:71]
    ds_read_b128 a[24:27], v46 offset:38912
    v_mfma_f32_16x16x32_bf16 v[72:75], a[40:43], a[56:59], v[72:75]
    ds_read_b128 a[28:31], v46 offset:40960
    ds_read_b64_tr_b16 a[8:9], v56 offset:35072
    v_mfma_f32_16x16x32_bf16 v[76:79], a[40:43], a[60:63], v[76:79]
    ds_read_b64_tr_b16 a[10:11], v56 offset:36608
    v_mfma_f32_16x16x32_bf16 v[80:83], a[40:43], a[64:67], v[80:83]
    v_mfma_f32_16x16x32_bf16 v[84:87], a[36:39], a[48:51], v[84:87]
    v_mfma_f32_16x16x32_bf16 v[88:91], a[36:39], a[52:55], v[88:91]
    v_mfma_f32_16x16x32_bf16 v[92:95], a[36:39], a[56:59], v[92:95]
    v_mfma_f32_16x16x32_bf16 v[96:99], a[36:39], a[60:63], v[96:99]
    v_mfma_f32_16x16x32_bf16 v[100:103], a[36:39], a[64:67], v[100:103]
    v_mfma_f32_16x16x32_bf16 v[104:107], a[48:51], a[44:47], v[104:107]
    v_mfma_f32_16x16x32_bf16 v[108:111], a[52:55], a[44:47], v[108:111]
    v_mfma_f32_16x16x32_bf16 v[112:115], a[56:59], a[44:47], v[112:115]
    v_mfma_f32_16x16x32_bf16 v[116:119], a[60:63], a[44:47], v[116:119]
    v_mfma_f32_16x16x32_bf16 v[120:123], a[64:67], a[44:47], v[120:123]
    s_waitcnt lgkmcnt(0)
    v_mfma_f32_16x16x32_bf16 v[124:127], a[72:75], a[32:35], v[124:127]
    s_lshl_b32 s48, s44, 3
    ds_read_b128 a[68:71], v52 offset:34816
    v_mfma_f32_16x16x32_bf16 v[128:131], a[32:35], a[32:35], v[128:131]
    buffer_load_dwordx2 v[234:235], off, s[36:39], s48 sc1
    v_mfma_f32_16x16x32_bf16 v[132:135], a[72:75], a[12:15], v[132:135]
    ds_read_b128 a[48:51], v48 offset:43008
    ds_read_b64_tr_b16 a[40:41], v56 offset:47232
    v_mfma_f32_16x16x32_bf16 v[136:139], a[12:15], a[12:15], v[136:139]
    ds_read_b64_tr_b16 a[42:43], v56 offset:48768
    v_mfma_f32_16x16x32_bf16 v[64:67], a[4:7], a[12:15], v[64:67]
    ds_read_b128 a[52:55], v48 offset:34816
    ds_read_b128 a[56:59], v48 offset:36864
    v_mfma_f32_16x16x32_bf16 v[68:71], a[4:7], a[16:19], v[68:71]
    buffer_load_dword v238, v30, s[28:31], 0 offen sc1
    v_mfma_f32_16x16x32_bf16 v[72:75], a[4:7], a[20:23], v[72:75]
    ds_read_b64_tr_b16 a[36:37], v56 offset:47104
    v_mfma_f32_16x16x32_bf16 v[76:79], a[4:7], a[24:27], v[76:79]
    ds_read_b64_tr_b16 a[38:39], v56 offset:48640
    ds_read_b128 a[60:63], v48 offset:38912
    v_mfma_f32_16x16x32_bf16 v[80:83], a[4:7], a[28:31], v[80:83]
    ds_read_b128 a[64:67], v48 offset:40960
    v_mfma_f32_16x16x32_bf16 v[84:87], a[0:3], a[12:15], v[84:87]
    buffer_load_dwordx4 v[140:143], v31, s[4:7], s67 offen offset:0
    v_mfma_f32_16x16x32_bf16 v[88:91], a[0:3], a[16:19], v[88:91]
    ds_read_b64_tr_b16 a[44:45], v56 offset:47360
    ds_read_b64_tr_b16 a[46:47], v56 offset:48896
    v_mfma_f32_16x16x32_bf16 v[92:95], a[0:3], a[20:23], v[92:95]
    v_mfma_f32_16x16x32_bf16 v[96:99], a[0:3], a[24:27], v[96:99]
    v_mfma_f32_16x16x32_bf16 v[100:103], a[0:3], a[28:31], v[100:103]
    buffer_load_dwordx4 v[144:147], v31, s[4:7], s67 offen offset:64
    v_mfma_f32_16x16x32_bf16 v[104:107], a[12:15], a[8:11], v[104:107]
    v_mfma_f32_16x16x32_bf16 v[108:111], a[16:19], a[8:11], v[108:111]
    v_mfma_f32_16x16x32_bf16 v[112:115], a[20:23], a[8:11], v[112:115]
    v_mfma_f32_16x16x32_bf16 v[116:119], a[24:27], a[8:11], v[116:119]
    v_mfma_f32_16x16x32_bf16 v[120:123], a[28:31], a[8:11], v[120:123]
    s_waitcnt lgkmcnt(0)
    s_barrier
    v_mfma_f32_16x16x32_bf16 v[124:127], a[72:75], a[68:71], v[124:127]
    s_add_u32 m0, s64, 0
    s_add_u32 s48, s65, 0
    v_mfma_f32_16x16x32_bf16 v[128:131], a[68:71], a[68:71], v[128:131]
    buffer_load_dwordx4 v4, s[12:15], s48 offen lds
    v_mfma_f32_16x16x32_bf16 v[132:135], a[72:75], a[48:51], v[132:135]
    v_mfma_f32_16x16x32_bf16 v[136:139], a[48:51], a[48:51], v[136:139]
    v_mfma_f32_16x16x32_bf16 v[64:67], a[40:43], a[48:51], v[64:67]
    v_mfma_f32_16x16x32_bf16 v[68:71], a[40:43], a[52:55], v[68:71]
    buffer_load_dwordx4 v5, s[12:15], s48 offen offset:1024 lds
    v_mfma_f32_16x16x32_bf16 v[72:75], a[40:43], a[56:59], v[72:75]
    v_mfma_f32_16x16x32_bf16 v[76:79], a[40:43], a[60:63], v[76:79]
    v_cndmask_b32_e64 v128, v128, v129, s[84:85]
    v_cndmask_b32_e64 v128, v128, v130, s[86:87]
    v_mfma_f32_16x16x32_bf16 v[80:83], a[40:43], a[64:67], v[80:83]
    v_cndmask_b32_e64 v128, v128, v131, s[88:89]
    v_mul_f32 v148, s95, v124
    v_mfma_f32_16x16x32_bf16 v[84:87], a[36:39], a[48:51], v[84:87]
    buffer_load_dwordx4 v6, s[12:15], s48 offen offset:2048 lds
    v_mfma_f32_16x16x32_bf16 v[88:91], a[36:39], a[52:55], v[88:91]
    v_fma_f32 v125, v148, v148, -s96
    v_fma_f32 v125, v128, s94, -v125
    v_max_f32 v125, s96, v125
    v_mfma_f32_16x16x32_bf16 v[92:95], a[36:39], a[56:59], v[92:95]
    v_rsq_f32 v149, v125
    v_cndmask_b32_e64 v136, v136, v137, s[84:85]
    v_cndmask_b32_e64 v136, v136, v138, s[86:87]
    v_mfma_f32_16x16x32_bf16 v[96:99], a[36:39], a[60:63], v[96:99]
    v_cndmask_b32_e64 v136, v136, v139, s[88:89]
    v_mul_f32 v150, s95, v132
    v_mfma_f32_16x16x32_bf16 v[100:103], a[36:39], a[64:67], v[100:103]
    buffer_load_dwordx4 v7, s[12:15], s48 offen offset:3072 lds
    v_mfma_f32_16x16x32_bf16 v[104:107], a[48:51], a[44:47], v[104:107]
    v_fma_f32 v133, v150, v150, -s96
    v_fma_f32 v133, v136, s94, -v133
    v_max_f32 v133, s96, v133
    v_rsq_f32 v151, v133
    v_lshlrev_b32 v152, 1, v253
    v_lshlrev_b32 v153, 1, v252
    v_mfma_f32_16x16x32_bf16 v[108:111], a[52:55], a[44:47], v[108:111]
    v_subrev_u32 v152, 154624, v152
    v_subrev_u32 v153, 154624, v153
    v_mfma_f32_16x16x32_bf16 v[112:115], a[56:59], a[44:47], v[112:115]
    ds_write_b32 v253, v148
    ds_write_b32 v253, v149 offset:512
    ds_write_b32 v252, v150
    v_mfma_f32_16x16x32_bf16 v[116:119], a[60:63], a[44:47], v[116:119]
    ds_write_b32 v252, v151 offset:512
    ds_write_b64 v152, v[148:149]
    v_mfma_f32_16x16x32_bf16 v[120:123], a[64:67], a[44:47], v[120:123]
    ds_write_b64 v153, v[150:151]
    v_mov_b32_dpp v154, v84 row_newbcast:0 row_mask:0xf bank_mask:0xf
    v_mov_b32_dpp v158, v64 row_newbcast:0 row_mask:0xf bank_mask:0xf
    v_mov_b32_dpp v155, v85 row_newbcast:0 row_mask:0xf bank_mask:0xf
    s_add_u32 m0, s64, 4096
    s_add_u32 s48, s65, 32768
    buffer_load_dwordx4 v4, s[12:15], s48 offen lds
    v_mov_b32_dpp v159, v65 row_newbcast:0 row_mask:0xf bank_mask:0xf
    v_mov_b32_dpp v156, v86 row_newbcast:0 row_mask:0xf bank_mask:0xf
    v_mov_b32_dpp v160, v66 row_newbcast:0 row_mask:0xf bank_mask:0xf
    v_mov_b32_dpp v157, v87 row_newbcast:0 row_mask:0xf bank_mask:0xf
    v_mov_b32_dpp v161, v67 row_newbcast:0 row_mask:0xf bank_mask:0xf
    ds_write_b32 v254, v104
    v_lshlrev_b32 v152, 3, v2
    buffer_load_dwordx4 v5, s[12:15], s48 offen offset:1024 lds
    v_add_u32 v152, 156672, v152
    v_lshlrev_b32 v153, 4, v3
    v_add_u32 v153, 155648, v153
    s_waitcnt lgkmcnt(0)
    s_barrier
    ds_read_b64 v[164:165], v152 offset:0
    ds_read_b64 v[166:167], v152 offset:128
    ds_read_b64 v[168:169], v152 offset:256
    buffer_load_dwordx4 v6, s[12:15], s48 offen offset:2048 lds
    ds_read_b64 v[170:171], v152 offset:384
    ds_read_b64 v[172:173], v152 offset:512
    ds_read_b32 v162, v255
    ds_read_b128 v[176:179], v153 offset:0
    ds_read_b128 v[180:183], v153 offset:64
    ds_read_b128 v[184:187], v153 offset:128
    ds_read_b128 v[188:191], v153 offset:192
    ds_read_b128 v[192:195], v153 offset:256
    buffer_load_dwordx4 v7, s[12:15], s48 offen offset:3072 lds
    ds_read_b128 v[196:199], v153 offset:512
    ds_read_b128 v[200:203], v153 offset:576
    ds_read_b128 v[204:207], v153 offset:640
    ds_read_b128 v[208:211], v153 offset:704
    s_mov_b32 s53, 0
    s_waitcnt vmcnt(11)
L_rdy:
    v_readfirstlane_b32 s40, v234
    v_readfirstlane_b32 s41, v235
    s_sub_u32 s42, s40, 0x01010101
    s_andn2_b32 s42, s42, s40
    s_and_b32 s42, s42, 0x80808080
    s_cbranch_scc1 L_rdy_wait
    s_sub_u32 s42, s41, 0x01010101
    s_andn2_b32 s42, s42, s41
    s_and_b32 s42, s42, 0x80808080
    s_cbranch_scc1 L_rdy_wait
    s_and_b32 s42, s40, 0xff
    s_mul_i32 s42, s42, 0x01010101
    s_cmp_eq_u32 s42, s40
    s_cselect_b32 s47, 1, 0
    s_cmp_eq_u32 s42, s41
    s_cselect_b32 s47, s47, 0
    s_waitcnt lgkmcnt(9)
    ds_read_b128 v[212:215], v153 offset:768
    v_pk_fma_f32 v[64:65], v[158:159], v[164:165], v[64:65] op_sel_hi:[1,0,1]
    s_add_u32 m0, s64, 32768
    s_add_u32 s48, s65, 262144
    buffer_load_dwordx4 v4, s[12:15], s48 offen lds
    v_pk_fma_f32 v[66:67], v[160:161], v[164:165], v[66:67] op_sel_hi:[1,0,1]
    v_pk_mul_f32 v[64:65], v[64:65], v[164:165] op_sel:[0,1] op_sel_hi:[1,1]
    v_pk_mul_f32 v[66:67], v[66:67], v[164:165] op_sel:[0,1] op_sel_hi:[1,1]
    v_cvt_pk_bf16_f32 v224, v64, v65
    v_cvt_pk_bf16_f32 v225, v66, v67
    v_pk_fma_f32 v[68:69], v[158:159], v[166:167], v[68:69] op_sel_hi:[1,0,1]
    v_pk_fma_f32 v[70:71], v[160:161], v[166:167], v[70:71] op_sel_hi:[1,0,1]
    v_pk_mul_f32 v[68:69], v[68:69], v[166:167] op_sel:[0,1] op_sel_hi:[1,1]
    buffer_load_dwordx4 v5, s[12:15], s48 offen offset:1024 lds
    v_pk_mul_f32 v[70:71], v[70:71], v[166:167] op_sel:[0,1] op_sel_hi:[1,1]
    v_cvt_pk_bf16_f32 v226, v68, v69
    v_cvt_pk_bf16_f32 v227, v70, v71
    v_pk_fma_f32 v[72:73], v[158:159], v[168:169], v[72:73] op_sel_hi:[1,0,1]
    v_pk_fma_f32 v[74:75], v[160:161], v[168:169], v[74:75] op_sel_hi:[1,0,1]
    v_pk_mul_f32 v[72:73], v[72:73], v[168:169] op_sel:[0,1] op_sel_hi:[1,1]
    v_pk_mul_f32 v[74:75], v[74:75], v[168:169] op_sel:[0,1] op_sel_hi:[1,1]
    buffer_load_dwordx4 v6, s[12:15], s48 offen offset:2048 lds
    v_cvt_pk_bf16_f32 v228, v72, v73
    v_cvt_pk_bf16_f32 v229, v74, v75
    v_pk_fma_f32 v[76:77], v[158:159], v[170:171], v[76:77] op_sel_hi:[1,0,1]
    v_pk_fma_f32 v[78:79], v[160:161], v[170:171], v[78:79] op_sel_hi:[1,0,1]
    v_pk_mul_f32 v[76:77], v[76:77], v[170:171] op_sel:[0,1] op_sel_hi:[1,1]
    v_pk_mul_f32 v[78:79], v[78:79], v[170:171] op_sel:[0,1] op_sel_hi:[1,1]
    v_cvt_pk_bf16_f32 v230, v76, v77
    v_cvt_pk_bf16_f32 v231, v78, v79
    buffer_load_dwordx4 v7, s[12:15], s48 offen offset:3072 lds
    v_pk_fma_f32 v[80:81], v[158:159], v[172:173], v[80:81] op_sel_hi:[1,0,1]
    v_pk_fma_f32 v[82:83], v[160:161], v[172:173], v[82:83] op_sel_hi:[1,0,1]
    v_pk_mul_f32 v[80:81], v[80:81], v[172:173] op_sel:[0,1] op_sel_hi:[1,1]
    v_pk_mul_f32 v[82:83], v[82:83], v[172:173] op_sel:[0,1] op_sel_hi:[1,1]
    v_cvt_pk_bf16_f32 v232, v80, v81
    v_cvt_pk_bf16_f32 v233, v82, v83
    v_pk_fma_f32 v[88:89], v[154:155], v[166:167], v[88:89] op_sel_hi:[1,0,1]
    v_pk_fma_f32 v[90:91], v[156:157], v[166:167], v[90:91] op_sel_hi:[1,0,1]
    s_add_u32 m0, s64, 36864
    s_add_u32 s48, s65, 294912
    buffer_load_dwordx4 v4, s[12:15], s48 offen lds
    v_cvt_pk_bf16_f32 v216, v88, v89
    v_cvt_pk_bf16_f32 v217, v90, v91
    v_pk_fma_f32 v[92:93], v[154:155], v[168:169], v[92:93] op_sel_hi:[1,0,1]
    v_pk_fma_f32 v[94:95], v[156:157], v[168:169], v[94:95] op_sel_hi:[1,0,1]
    v_cvt_pk_bf16_f32 v218, v92, v93
    v_cvt_pk_bf16_f32 v219, v94, v95
    v_pk_fma_f32 v[96:97], v[154:155], v[170:171], v[96:97] op_sel_hi:[1,0,1]
    v_pk_fma_f32 v[98:99], v[156:157], v[170:171], v[98:99] op_sel_hi:[1,0,1]
    buffer_load_dwordx4 v5, s[12:15], s48 offen offset:1024 lds
    v_cvt_pk_bf16_f32 v220, v96, v97
    v_cvt_pk_bf16_f32 v221, v98, v99
    v_pk_fma_f32 v[100:101], v[154:155], v[172:173], v[100:101] op_sel_hi:[1,0,1]
    v_pk_fma_f32 v[102:103], v[156:157], v[172:173], v[102:103] op_sel_hi:[1,0,1]
    v_cvt_pk_bf16_f32 v222, v100, v101
    v_cvt_pk_bf16_f32 v223, v102, v103
    s_waitcnt lgkmcnt(0)
    v_pk_fma_f32 v[104:105], v[176:177], v[162:163], v[104:105] op_sel_hi:[1,0,1]
    buffer_load_dwordx4 v6, s[12:15], s48 offen offset:2048 lds
    v_pk_fma_f32 v[106:107], v[178:179], v[162:163], v[106:107] op_sel_hi:[1,0,1]
    v_pk_mul_f32 v[104:105], v[104:105], v[196:197]
    v_pk_mul_f32 v[106:107], v[106:107], v[198:199]
    v_cvt_pk_bf16_f32 v124, v104, v105
    v_cvt_pk_bf16_f32 v125, v106, v107
    v_pk_fma_f32 v[108:109], v[180:181], v[162:163], v[108:109] op_sel_hi:[1,0,1]
    v_pk_fma_f32 v[110:111], v[182:183], v[162:163], v[110:111] op_sel_hi:[1,0,1]
    v_pk_mul_f32 v[108:109], v[108:109], v[200:201]
    buffer_load_dwordx4 v7, s[12:15], s48 offen offset:3072 lds
    v_pk_mul_f32 v[110:111], v[110:111], v[202:203]
    v_cvt_pk_bf16_f32 v126, v108, v109
    v_cvt_pk_bf16_f32 v127, v110, v111
    v_pk_fma_f32 v[112:113], v[184:185], v[162:163], v[112:113] op_sel_hi:[1,0,1]
    v_pk_fma_f32 v[114:115], v[186:187], v[162:163], v[114:115] op_sel_hi:[1,0,1]
    v_pk_mul_f32 v[112:113], v[112:113], v[204:205]
    v_pk_mul_f32 v[114:115], v[114:115], v[206:207]
    s_add_u32 s49, s63, 0
    s_add_u32 m0, s62, 0
    s_nop 0
    buffer_load_dwordx4 v8, s[16:19], s49 offen lds
    v_cvt_pk_bf16_f32 v128, v112, v113
    v_cvt_pk_bf16_f32 v129, v114, v115
    v_pk_fma_f32 v[116:117], v[188:189], v[162:163], v[116:117] op_sel_hi:[1,0,1]
    v_pk_fma_f32 v[118:119], v[190:191], v[162:163], v[118:119] op_sel_hi:[1,0,1]
    v_pk_mul_f32 v[116:117], v[116:117], v[208:209]
    v_pk_mul_f32 v[118:119], v[118:119], v[210:211]
    v_cvt_pk_bf16_f32 v130, v116, v117
    v_cvt_pk_bf16_f32 v131, v118, v119
    buffer_load_dwordx4 v9, s[16:19], s49 offen offset:1024 lds
    v_pk_fma_f32 v[120:121], v[192:193], v[162:163], v[120:121] op_sel_hi:[1,0,1]
    v_pk_fma_f32 v[122:123], v[194:195], v[162:163], v[122:123] op_sel_hi:[1,0,1]
    v_pk_mul_f32 v[120:121], v[120:121], v[212:213]
    v_pk_mul_f32 v[122:123], v[122:123], v[214:215]
    v_cvt_pk_bf16_f32 v132, v120, v121
    v_cvt_pk_bf16_f32 v133, v122, v123
    v_mfma_f32_16x16x16_bf16 v[64:67], v[224:225], v[216:217], v[248:251]
    v_mfma_f32_16x16x16_bf16 v[68:71], v[226:227], v[216:217], v[240:243]
    buffer_load_dwordx4 v10, s[16:19], s49 offen offset:2048 lds
    v_mfma_f32_16x16x16_bf16 v[72:75], v[226:227], v[218:219], v[244:247]
    v_mfma_f32_16x16x16_bf16 v[76:79], v[228:229], v[218:219], v[240:243]
    v_mfma_f32_16x16x16_bf16 v[80:83], v[228:229], v[220:221], v[244:247]
    v_mfma_f32_16x16x16_bf16 v[84:87], v[230:231], v[220:221], v[240:243]
    v_mfma_f32_16x16x16_bf16 v[88:91], v[230:231], v[222:223], v[244:247]
    v_mfma_f32_16x16x16_bf16 v[92:95], v[232:233], v[222:223], v[240:243]
    v_max3_f32 v176, v64, v65, v66
    s_nop 1
    v_max3_f32 v177, v72, v73, v74
    buffer_load_dwordx4 v11, s[16:19], s49 offen offset:3072 lds
    v_max3_f32 v178, v80, v81, v82
    s_nop 0
    v_max3_f32 v179, v88, v89, v90
    v_max3_f32 v176, v176, v67, v68
    v_max3_f32 v177, v177, v75, v76
    v_max3_f32 v178, v178, v83, v84
    v_max3_f32 v179, v179, v91, v92
    v_max3_f32 v176, v176, v69, v70
    v_max3_f32 v177, v177, v77, v78
    s_add_u32 m0, s62, 4096
    s_nop 0
    buffer_load_dwordx4 v12, s[16:19], s49 offen lds
    v_max3_f32 v178, v178, v85, v86
    v_max3_f32 v179, v179, v93, v94
    v_max_f32 v176, v176, v71
    v_max_f32 v177, v177, v79
    v_max_f32 v178, v178, v87
    v_max_f32 v179, v179, v95
    v_mov_b32 v180, v176
    v_mov_b32 v181, v177
    buffer_load_dwordx4 v13, s[16:19], s49 offen offset:1024 lds
    v_mov_b32 v182, v178
    v_mov_b32 v183, v179
    v_permlane16_swap_b32 v176, v180
    v_permlane16_swap_b32 v177, v181
    v_permlane16_swap_b32 v178, v182
    v_permlane16_swap_b32 v179, v183
    v_max_f32 v176, v176, v180
    buffer_load_dwordx4 v14, s[16:19], s49 offen offset:2048 lds
    v_max_f32 v177, v177, v181
    v_max_f32 v178, v178, v182
    v_max_f32 v179, v179, v183
    v_mov_b32 v180, v176
    v_mov_b32 v181, v177
    v_mov_b32 v182, v178
    v_mov_b32 v183, v179
    v_permlane32_swap_b32 v176, v180
    buffer_load_dwordx4 v15, s[16:19], s49 offen offset:3072 lds
    v_permlane32_swap_b32 v177, v181
    v_permlane32_swap_b32 v178, v182
    v_permlane32_swap_b32 v179, v183
    v_max_f32 v176, v176, v180
    v_max_f32 v177, v177, v181
    v_max_f32 v178, v178, v182
    v_max_f32 v179, v179, v183
    v_mul_f32 v184, s97, v167
    s_add_u32 m0, s62, 8192
    s_nop 0
    buffer_load_dwordx4 v16, s[16:19], s49 offen lds
    v_mul_f32 v186, s97, v169
    v_mul_f32 v188, s97, v171
    v_mul_f32 v190, s97, v173
    v_mul_f32 v185, v184, v176
    v_mul_f32 v187, v186, v177
    v_mul_f32 v189, v188, v178
    v_mul_f32 v191, v190, v179
    v_pk_fma_f32 v[64:65], v[64:65], v[184:185], v[184:185] op_sel:[0,0,1] op_sel_hi:[1,0,1] neg_lo:[0,0,1] neg_hi:[0,0,1]
    buffer_load_dwordx4 v17, s[16:19], s49 offen offset:1024 lds
    v_pk_fma_f32 v[66:67], v[66:67], v[184:185], v[184:185] op_sel:[0,0,1] op_sel_hi:[1,0,1] neg_lo:[0,0,1] neg_hi:[0,0,1]
    v_pk_fma_f32 v[68:69], v[68:69], v[184:185], v[184:185] op_sel:[0,0,1] op_sel_hi:[1,0,1] neg_lo:[0,0,1] neg_hi:[0,0,1]
    v_pk_fma_f32 v[70:71], v[70:71], v[184:185], v[184:185] op_sel:[0,0,1] op_sel_hi:[1,0,1] neg_lo:[0,0,1] neg_hi:[0,0,1]
    v_pk_fma_f32 v[72:73], v[72:73], v[186:187], v[186:187] op_sel:[0,0,1] op_sel_hi:[1,0,1] neg_lo:[0,0,1] neg_hi:[0,0,1]
    v_pk_fma_f32 v[74:75], v[74:75], v[186:187], v[186:187] op_sel:[0,0,1] op_sel_hi:[1,0,1] neg_lo:[0,0,1] neg_hi:[0,0,1]
    v_pk_fma_f32 v[76:77], v[76:77], v[186:187], v[186:187] op_sel:[0,0,1] op_sel_hi:[1,0,1] neg_lo:[0,0,1] neg_hi:[0,0,1]
    v_pk_fma_f32 v[78:79], v[78:79], v[186:187], v[186:187] op_sel:[0,0,1] op_sel_hi:[1,0,1] neg_lo:[0,0,1] neg_hi:[0,0,1]
    v_pk_fma_f32 v[80:81], v[80:81], v[188:189], v[188:189] op_sel:[0,0,1] op_sel_hi:[1,0,1] neg_lo:[0,0,1] neg_hi:[0,0,1]
    buffer_load_dwordx4 v18, s[16:19], s49 offen offset:2048 lds
    v_pk_fma_f32 v[82:83], v[82:83], v[188:189], v[188:189] op_sel:[0,0,1] op_sel_hi:[1,0,1] neg_lo:[0,0,1] neg_hi:[0,0,1]
    v_pk_fma_f32 v[84:85], v[84:85], v[188:189], v[188:189] op_sel:[0,0,1] op_sel_hi:[1,0,1] neg_lo:[0,0,1] neg_hi:[0,0,1]
    v_pk_fma_f32 v[86:87], v[86:87], v[188:189], v[188:189] op_sel:[0,0,1] op_sel_hi:[1,0,1] neg_lo:[0,0,1] neg_hi:[0,0,1]
    v_pk_fma_f32 v[88:89], v[88:89], v[190:191], v[190:191] op_sel:[0,0,1] op_sel_hi:[1,0,1] neg_lo:[0,0,1] neg_hi:[0,0,1]
    v_pk_fma_f32 v[90:91], v[90:91], v[190:191], v[190:191] op_sel:[0,0,1] op_sel_hi:[1,0,1] neg_lo:[0,0,1] neg_hi:[0,0,1]
    v_pk_fma_f32 v[92:93], v[92:93], v[190:191], v[190:191] op_sel:[0,0,1] op_sel_hi:[1,0,1] neg_lo:[0,0,1] neg_hi:[0,0,1]
    v_pk_fma_f32 v[94:95], v[94:95], v[190:191], v[190:191] op_sel:[0,0,1] op_sel_hi:[1,0,1] neg_lo:[0,0,1] neg_hi:[0,0,1]
    v_exp_f32 v64, v64
    v_exp_f32 v65, v65
    v_exp_f32 v66, v66
    v_exp_f32 v67, v67
    v_exp_f32 v68, v68
    v_exp_f32 v69, v69
    v_exp_f32 v70, v70
    v_exp_f32 v71, v71
    v_cvt_pk_bf16_f32 v104, v64, v65
    v_cvt_pk_bf16_f32 v105, v66, v67
    v_cvt_pk_bf16_f32 v106, v68, v69
    v_cvt_pk_bf16_f32 v107, v70, v71
    s_nop 1
    v_mfma_f32_16x16x32_bf16 v[192:195], v[124:127], v[104:107], 0
    v_mfma_f32_16x16x32_bf16 v[208:211], a[72:75], v[104:107], 0
    v_exp_f32 v72, v72
    v_exp_f32 v73, v73
    v_exp_f32 v74, v74
    v_exp_f32 v75, v75
    v_exp_f32 v76, v76
    v_exp_f32 v77, v77
    v_exp_f32 v78, v78
    v_exp_f32 v79, v79
    v_cvt_pk_bf16_f32 v108, v72, v73
    v_cvt_pk_bf16_f32 v109, v74, v75
    v_cvt_pk_bf16_f32 v110, v76, v77
    v_cvt_pk_bf16_f32 v111, v78, v79
    s_nop 1
    v_mfma_f32_16x16x32_bf16 v[196:199], v[126:129], v[108:111], 0
    v_mfma_f32_16x16x32_bf16 v[212:215], a[72:75], v[108:111], 0
    v_exp_f32 v80, v80
    v_exp_f32 v81, v81
    v_exp_f32 v82, v82
    v_exp_f32 v83, v83
    v_exp_f32 v84, v84
    v_exp_f32 v85, v85
    v_exp_f32 v86, v86
    v_exp_f32 v87, v87
    v_cvt_pk_bf16_f32 v112, v80, v81
    v_cvt_pk_bf16_f32 v113, v82, v83
    v_cvt_pk_bf16_f32 v114, v84, v85
    v_cvt_pk_bf16_f32 v115, v86, v87
    s_nop 1
    v_mfma_f32_16x16x32_bf16 v[200:203], v[128:131], v[112:115], 0
    v_mfma_f32_16x16x32_bf16 v[216:219], a[72:75], v[112:115], 0
    v_exp_f32 v88, v88
    v_exp_f32 v89, v89
    v_exp_f32 v90, v90
    v_exp_f32 v91, v91
    v_exp_f32 v92, v92
    v_exp_f32 v93, v93
    v_exp_f32 v94, v94
    v_exp_f32 v95, v95
    v_cvt_pk_bf16_f32 v116, v88, v89
    v_cvt_pk_bf16_f32 v117, v90, v91
    v_cvt_pk_bf16_f32 v118, v92, v93
    v_cvt_pk_bf16_f32 v119, v94, v95
    s_nop 1
    v_mfma_f32_16x16x32_bf16 v[204:207], v[130:133], v[116:119], 0
    v_mfma_f32_16x16x32_bf16 v[220:223], a[72:75], v[116:119], 0
    v_rcp_f32 v208, v208
    v_rcp_f32 v212, v212
    v_rcp_f32 v216, v216
    s_nop 4
    v_rcp_f32 v220, v220
    v_pk_mul_f32 v[192:193], v[192:193], v[208:209] op_sel_hi:[1,0]
    v_pk_mul_f32 v[194:195], v[194:195], v[208:209] op_sel_hi:[1,0]
    v_pk_mul_f32 v[196:197], v[196:197], v[212:213] op_sel_hi:[1,0]
    v_pk_mul_f32 v[198:199], v[198:199], v[212:213] op_sel_hi:[1,0]
    v_pk_mul_f32 v[200:201], v[200:201], v[216:217] op_sel_hi:[1,0]
    v_pk_mul_f32 v[202:203], v[202:203], v[216:217] op_sel_hi:[1,0]
    v_pk_mul_f32 v[204:205], v[204:205], v[220:221] op_sel_hi:[1,0]
    v_pk_mul_f32 v[206:207], v[206:207], v[220:221] op_sel_hi:[1,0]
    v_cvt_pk_bf16_f32 v64, v192, v193
    v_cvt_pk_bf16_f32 v65, v194, v195
    v_cvt_pk_bf16_f32 v66, v196, v197
    v_cvt_pk_bf16_f32 v67, v198, v199
    v_cvt_pk_bf16_f32 v68, v200, v201
    v_cvt_pk_bf16_f32 v69, v202, v203
    v_cvt_pk_bf16_f32 v70, v204, v205
    v_cvt_pk_bf16_f32 v71, v206, v207
    s_add_u32 s40, s66, 32768
    v_permlane16_swap_b32 v64, v66
    v_permlane16_swap_b32 v65, v67
    v_permlane16_swap_b32 v68, v70
    v_permlane16_swap_b32 v69, v71
    buffer_store_dwordx4 v[64:67], v26, s[28:31], s66 offen sc1
    buffer_store_dwordx4 v[68:71], v26, s[28:31], s40 offen sc1
    v_mov_b32 v160, 0x3f803f80
    v_mov_b32 v161, 0x3f803f80
    v_mov_b32 v162, 0x3f803f80
    v_mov_b32 v163, 0x3f803f80
    s_add_u32 s49, s63, s3
    s_add_u32 m0, s62, 45056
    s_nop 0
    buffer_load_dwordx4 v8, s[16:19], s49 offen lds
    buffer_load_dwordx4 v9, s[16:19], s49 offen offset:1024 lds
    buffer_load_dwordx4 v10, s[16:19], s49 offen offset:2048 lds
    buffer_load_dwordx4 v11, s[16:19], s49 offen offset:3072 lds
    s_add_u32 m0, s62, 49152
    s_nop 0
    buffer_load_dwordx4 v12, s[16:19], s49 offen lds
    s_waitcnt vmcnt(5)
    v_mov_b32 v62, 1
    s_cmp_eq_u32 s47, 1
    s_cbranch_scc0 L_pub_slow1
    buffer_store_dword v62, v29, s[28:31], 0 offen
L_pub_done1:
    buffer_load_dwordx4 v13, s[16:19], s49 offen offset:1024 lds
    buffer_load_dwordx4 v14, s[16:19], s49 offen offset:2048 lds
    buffer_load_dwordx4 v15, s[16:19], s49 offen offset:3072 lds
    s_add_u32 m0, s62, 53248
    s_nop 0
    buffer_load_dwordx4 v16, s[16:19], s49 offen lds
    buffer_load_dwordx4 v17, s[16:19], s49 offen offset:1024 lds
    buffer_load_dwordx4 v18, s[16:19], s49 offen offset:2048 lds
    s_barrier
    ds_read_b64_tr_b16 a[0:1], v23 offset:0
    ds_read_b64_tr_b16 a[2:3], v23 offset:5632
    ds_read_b64_tr_b16 a[4:5], v23 offset:32
    ds_read_b64_tr_b16 a[6:7], v23 offset:5664
    ds_read_b64_tr_b16 a[8:9], v23 offset:64
    ds_read_b64_tr_b16 a[10:11], v23 offset:5696
    ds_read_b64_tr_b16 a[12:13], v23 offset:11264
    ds_read_b64_tr_b16 a[14:15], v23 offset:16896
    ds_read_b64_tr_b16 a[16:17], v23 offset:11296
    ds_read_b64_tr_b16 a[18:19], v23 offset:16928
    ds_read_b64_tr_b16 a[20:21], v23 offset:11328
    ds_read_b64_tr_b16 a[22:23], v23 offset:16960
    s_waitcnt lgkmcnt(6)
    v_mfma_f32_16x16x32_bf16 v[148:151], a[0:3], v[160:163], 0
    ds_read_b64_tr_b16 a[24:25], v23 offset:22528
    ds_read_b64_tr_b16 a[26:27], v23 offset:28160
    v_mfma_f32_16x16x32_bf16 v[152:155], a[4:7], v[160:163], 0
    ds_read_b64_tr_b16 a[28:29], v23 offset:22560
    ds_read_b64_tr_b16 a[30:31], v23 offset:28192
    v_mfma_f32_16x16x32_bf16 v[156:159], a[8:11], v[160:163], 0
    ds_read_b64_tr_b16 a[32:33], v23 offset:22592
    ds_read_b64_tr_b16 a[34:35], v23 offset:28224
    s_waitcnt lgkmcnt(6)
    v_mfma_f32_16x16x32_bf16 v[148:151], a[12:15], v[160:163], v[148:151]
    ds_read_b64_tr_b16 a[36:37], v23 offset:33792
    ds_read_b64_tr_b16 a[38:39], v23 offset:39424
    v_mfma_f32_16x16x32_bf16 v[152:155], a[16:19], v[160:163], v[152:155]
    ds_read_b64_tr_b16 a[40:41], v23 offset:33824
    ds_read_b64_tr_b16 a[42:43], v23 offset:39456
    v_mfma_f32_16x16x32_bf16 v[156:159], a[20:23], v[160:163], v[156:159]
    ds_read_b64_tr_b16 a[44:45], v23 offset:33856
    ds_read_b64_tr_b16 a[46:47], v23 offset:39488
    s_waitcnt lgkmcnt(6)
    v_mfma_f32_16x16x32_bf16 v[148:151], a[24:27], v[160:163], v[148:151]
    v_mfma_f32_16x16x32_bf16 v[152:155], a[28:31], v[160:163], v[152:155]
    v_mfma_f32_16x16x32_bf16 v[156:159], a[32:35], v[160:163], v[156:159]
    s_waitcnt lgkmcnt(0)
    v_mfma_f32_16x16x32_bf16 v[148:151], a[36:39], v[160:163], v[148:151]
    v_mfma_f32_16x16x32_bf16 v[152:155], a[40:43], v[160:163], v[152:155]
    v_mfma_f32_16x16x32_bf16 v[156:159], a[44:47], v[160:163], v[156:159]
    v_xor_b32 v20, 32, v19
    v_xor_b32 v21, 64, v19
    v_xor_b32 v22, 96, v19
    s_lshl_b32 s41, s46, 14
    s_add_u32 s54, s41, 65536
    s_lshl_b32 s40, s45, 11
    s_add_u32 s55, s41, s40
    s_add_u32 s55, s55, 131072
    s_bfe_u32 s40, s44, 65537
    s_xor_b32 s40, s40, s46
    s_lshl_b32 s40, s40, 12
    s_add_u32 s57, s40, 131072
    v_lshlrev_b32 v59, 3, v2
    v_mov_b32 v57, 0x80000000
    v_cndmask_b32_e64 v27, v57, v59, s[90:91]
    v_lshl_add_u32 v28, v3, 8, v59
    s_lshl_b32 s40, s46, 10
    s_add_u32 s99, s40, 4096
    s_lshl_b32 s41, s45, 7
    s_add_u32 s56, s99, s41
    s_mul_i32 s61, s46, 360448
    s_add_u32 s61, s61, s41
    s_lshr_b32 s40, s45, 31
    s_mul_i32 s69, s40, 20480
    s_mul_i32 s70, s40, -24576
    s_lshl_b32 s40, s70, 3
    s_add_u32 s68, s61, s40
    s_lshl_b32 s40, s69, 3
    s_add_u32 s61, s61, s40
    s_mul_i32 s42, s45, 11
    s_min_u32 s42, s42, 75
    s_mul_i32 s41, s46, 3
    s_add_u32 s40, s41, 0
    s_add_u32 s43, s40, s42
    s_lshr_b32 s58, s43, 1
    s_lshl_b32 s58, s58, 12
    s_and_b32 s43, s43, 1
    s_lshl_b32 s43, s43, 9
    s_add_u32 s58, s58, s43
    s_cmp_gt_u32 s40, 10
    s_cselect_b32 s58, 0x7fff0000, s58
    s_add_u32 s40, s41, 1
    s_add_u32 s43, s40, s42
    s_lshr_b32 s59, s43, 1
    s_lshl_b32 s59, s59, 12
    s_and_b32 s43, s43, 1
    s_lshl_b32 s43, s43, 9
    s_add_u32 s59, s59, s43
    s_cmp_gt_u32 s40, 10
    s_cselect_b32 s59, 0x7fff0000, s59
    s_add_u32 s40, s41, 2
    s_add_u32 s43, s40, s42
    s_lshr_b32 s60, s43, 1
    s_lshl_b32 s60, s60, 12
    s_and_b32 s43, s43, 1
    s_lshl_b32 s43, s43, 9
    s_add_u32 s60, s60, s43
    s_cmp_gt_u32 s40, 10
    s_cselect_b32 s60, 0x7fff0000, s60
    s_add_u32 s32, s28, 196608
    s_addc_u32 s33, s29, 0
    s_mul_i32 s40, s46, 45056
    s_add_u32 s41, s46, 0
    s_and_b32 s41, s41, 3
    s_lshl_b32 s41, s41, 10
    s_add_u32 s41, s41, s40
    v_add_u32 v32, s41, v1
    s_add_u32 s41, s46, 1
    s_and_b32 s41, s41, 3
    s_lshl_b32 s41, s41, 10
    s_add_u32 s41, s41, s40
    v_add_u32 v33, s41, v1
    s_add_u32 s41, s46, 2
    s_and_b32 s41, s41, 3
    s_lshl_b32 s41, s41, 10
    s_add_u32 s41, s41, s40
    v_add_u32 v34, s41, v1
    s_add_u32 s41, s46, 3
    s_and_b32 s41, s41, 3
    s_lshl_b32 s41, s41, 10
    s_add_u32 s41, s41, s40
    v_add_u32 v35, s41, v1
    v_add_u32 v39, s52, v1
    s_sub_u32 s41, s46, 1
    s_and_b32 s41, s41, 3
    s_lshl_b32 s41, s41, 12
    s_add_u32 s41, s41, 0
    v_add_u32 v36, s41, v1
    s_sub_u32 s41, s46, 2
    s_and_b32 s41, s41, 3
    s_lshl_b32 s41, s41, 12
    s_add_u32 s41, s41, 16384
    v_add_u32 v37, s41, v1
    s_sub_u32 s41, s46, 3
    s_and_b32 s41, s41, 3
    s_lshl_b32 s41, s41, 12
    s_add_u32 s41, s41, 32768
    v_add_u32 v38, s41, v1
    v_permlane16_swap_b32 v140, v142
    v_permlane16_swap_b32 v141, v143
    v_permlane16_swap_b32 v144, v146
    v_permlane16_swap_b32 v145, v147
    v_lshlrev_b32 v164, 16, v140
    v_and_b32 v165, 0xffff0000, v140
    v_lshlrev_b32 v166, 16, v141
    v_and_b32 v167, 0xffff0000, v141
    v_lshlrev_b32 v168, 16, v142
    v_and_b32 v169, 0xffff0000, v142
    v_lshlrev_b32 v170, 16, v143
    v_and_b32 v171, 0xffff0000, v143
    v_lshlrev_b32 v172, 16, v144
    v_and_b32 v173, 0xffff0000, v144
    v_lshlrev_b32 v174, 16, v145
    v_and_b32 v175, 0xffff0000, v145
    v_lshlrev_b32 v176, 16, v146
    v_and_b32 v177, 0xffff0000, v146
    v_lshlrev_b32 v178, 16, v147
    v_and_b32 v179, 0xffff0000, v147
    s_mov_b32 s53, 0
    buffer_load_dword v63, v30, s[28:31], 0 offen sc1
L_poll1:
    buffer_load_dword v60, v30, s[28:31], 0 offen sc1
    s_waitcnt vmcnt(1)
    v_cmp_le_u32 vcc, 1, v63
    s_nop 0
    s_cmp_eq_u64 vcc, -1
    s_cbranch_scc1 L_poll_ok1
    buffer_load_dword v63, v30, s[28:31], 0 offen sc1
    s_waitcnt vmcnt(1)
    v_cmp_le_u32 vcc, 1, v60
    s_nop 0
    s_cmp_eq_u64 vcc, -1
    s_cbranch_scc1 L_poll_ok1
    s_add_u32 s53, s53, 1
    s_cmp_lt_u32 s53, 0x20000
    s_cbranch_scc1 L_poll1
    s_branch L_end
L_poll_ok1:
    s_cmp_eq_u32 s47, 1
    s_cbranch_scc0 L_acq_slow1
L_acq_done1:
    buffer_load_dwordx4 a[192:195], v1, s[28:31], s54 offen offset:0 sc1
    buffer_load_dwordx4 a[196:199], v1, s[28:31], s54 offen offset:1024 sc1
    buffer_load_dwordx4 a[200:203], v1, s[28:31], s54 offen offset:2048 sc1
    buffer_load_dwordx4 a[204:207], v1, s[28:31], s54 offen offset:3072 sc1
    s_add_u32 s48, s54, 4096
    buffer_load_dwordx4 a[208:211], v1, s[28:31], s48 offen offset:0 sc1
    buffer_load_dwordx4 a[212:215], v1, s[28:31], s48 offen offset:1024 sc1
    buffer_load_dwordx4 a[216:219], v1, s[28:31], s48 offen offset:2048 sc1
    buffer_load_dwordx4 a[220:223], v1, s[28:31], s48 offen offset:3072 sc1
    s_barrier
    s_waitcnt lgkmcnt(0)
    ds_read_b64_tr_b16 a[48:49], v24 offset:0
    ds_read_b64_tr_b16 a[50:51], v24 offset:5632
    ds_read_b64_tr_b16 a[52:53], v24 offset:32
    ds_read_b64_tr_b16 a[54:55], v24 offset:5664
    ds_read_b64_tr_b16 a[56:57], v24 offset:64
    ds_read_b64_tr_b16 a[58:59], v24 offset:5696
    ds_read_b64_tr_b16 a[60:61], v24 offset:11264
    ds_read_b64_tr_b16 a[62:63], v24 offset:16896
    ds_read_b64_tr_b16 a[64:65], v24 offset:11296
    ds_read_b64_tr_b16 a[66:67], v24 offset:16928
    ds_read_b64_tr_b16 a[68:69], v24 offset:11328
    ds_read_b64_tr_b16 a[70:71], v24 offset:16960
    s_waitcnt lgkmcnt(6)
    v_mfma_f32_16x16x32_bf16 v[148:151], a[48:51], v[160:163], v[148:151]
    ds_read_b64_tr_b16 a[72:73], v24 offset:22528
    ds_read_b64_tr_b16 a[74:75], v24 offset:28160
    v_mfma_f32_16x16x32_bf16 v[152:155], a[52:55], v[160:163], v[152:155]
    ds_read_b64_tr_b16 a[76:77], v24 offset:22560
    ds_read_b64_tr_b16 a[78:79], v24 offset:28192
    v_mfma_f32_16x16x32_bf16 v[156:159], a[56:59], v[160:163], v[156:159]
    ds_read_b64_tr_b16 a[80:81], v24 offset:22592
    ds_read_b64_tr_b16 a[82:83], v24 offset:28224
    s_waitcnt lgkmcnt(6)
    v_mfma_f32_16x16x32_bf16 v[148:151], a[60:63], v[160:163], v[148:151]
    ds_read_b64_tr_b16 a[84:85], v24 offset:33792
    ds_read_b64_tr_b16 a[86:87], v24 offset:39424
    v_mfma_f32_16x16x32_bf16 v[152:155], a[64:67], v[160:163], v[152:155]
    ds_read_b64_tr_b16 a[88:89], v24 offset:33824
    ds_read_b64_tr_b16 a[90:91], v24 offset:39456
    v_mfma_f32_16x16x32_bf16 v[156:159], a[68:71], v[160:163], v[156:159]
    ds_read_b64_tr_b16 a[92:93], v24 offset:33856
    ds_read_b64_tr_b16 a[94:95], v24 offset:39488
    s_waitcnt lgkmcnt(6)
    v_mfma_f32_16x16x32_bf16 v[148:151], a[72:75], v[160:163], v[148:151]
    v_mfma_f32_16x16x32_bf16 v[152:155], a[76:79], v[160:163], v[152:155]
    v_mfma_f32_16x16x32_bf16 v[156:159], a[80:83], v[160:163], v[156:159]
    s_waitcnt lgkmcnt(0)
    v_mfma_f32_16x16x32_bf16 v[148:151], a[84:87], v[160:163], v[148:151]
    v_mfma_f32_16x16x32_bf16 v[152:155], a[88:91], v[160:163], v[152:155]
    v_mfma_f32_16x16x32_bf16 v[156:159], a[92:95], v[160:163], v[156:159]
    ds_read_b64_tr_b16 v[64:65], v19 offset:0
    ds_read_b64_tr_b16 v[66:67], v19 offset:512
    ds_read_b64_tr_b16 v[68:69], v20 offset:0
    ds_read_b64_tr_b16 v[70:71], v20 offset:512
    ds_read_b64_tr_b16 v[72:73], v21 offset:0
    ds_read_b64_tr_b16 v[74:75], v21 offset:512
    ds_read_b64_tr_b16 v[76:77], v22 offset:0
    ds_read_b64_tr_b16 v[78:79], v22 offset:512
    ds_read_b64_tr_b16 v[80:81], v19 offset:4096
    ds_read_b64_tr_b16 v[82:83], v19 offset:4608
    ds_read_b64_tr_b16 v[84:85], v20 offset:4096
    ds_read_b64_tr_b16 v[86:87], v20 offset:4608
    ds_read_b64_tr_b16 v[88:89], v21 offset:4096
    ds_read_b64_tr_b16 v[90:91], v21 offset:4608
    ds_read_b64_tr_b16 v[92:93], v22 offset:4096
    ds_read_b64_tr_b16 v[94:95], v22 offset:4608
    s_barrier
    s_waitcnt vmcnt(7) lgkmcnt(8)
    v_mfma_f32_16x16x32_bf16 v[164:167], v[64:67], a[192:195], v[164:167]
    ds_read_b64_tr_b16 v[96:97], v19 offset:8192
    ds_read_b64_tr_b16 v[98:99], v19 offset:8704
    s_add_u32 s48, s54, 8192
    buffer_load_dwordx4 a[224:227], v1, s[28:31], s48 offen offset:0 sc1
    v_mfma_f32_16x16x32_bf16 v[168:171], v[68:71], a[192:195], v[168:171]
    ds_read_b64_tr_b16 v[100:101], v20 offset:8192
    ds_read_b64_tr_b16 v[102:103], v20 offset:8704
    v_mfma_f32_16x16x32_bf16 v[172:175], v[72:75], a[192:195], v[172:175]
    ds_read_b64_tr_b16 v[104:105], v21 offset:8192
    ds_read_b64_tr_b16 v[106:107], v21 offset:8704
    v_mfma_f32_16x16x32_bf16 v[176:179], v[76:79], a[192:195], v[176:179]
    ds_read_b64_tr_b16 v[108:109], v22 offset:8192
    ds_read_b64_tr_b16 v[110:111], v22 offset:8704
    s_waitcnt vmcnt(7) lgkmcnt(8)
    v_mfma_f32_16x16x32_bf16 v[164:167], v[80:83], a[196:199], v[164:167]
    ds_read_b64_tr_b16 v[64:65], v19 offset:12288
    ds_read_b64_tr_b16 v[66:67], v19 offset:12800
    buffer_load_dwordx4 a[228:231], v1, s[28:31], s48 offen offset:1024 sc1
    v_mfma_f32_16x16x32_bf16 v[168:171], v[84:87], a[196:199], v[168:171]
    ds_read_b64_tr_b16 v[68:69], v20 offset:12288
    ds_read_b64_tr_b16 v[70:71], v20 offset:12800
    v_mfma_f32_16x16x32_bf16 v[172:175], v[88:91], a[196:199], v[172:175]
    ds_read_b64_tr_b16 v[72:73], v21 offset:12288
    ds_read_b64_tr_b16 v[74:75], v21 offset:12800
    v_mfma_f32_16x16x32_bf16 v[176:179], v[92:95], a[196:199], v[176:179]
    ds_read_b64_tr_b16 v[76:77], v22 offset:12288
    ds_read_b64_tr_b16 v[78:79], v22 offset:12800
    s_waitcnt vmcnt(7) lgkmcnt(8)
    v_mfma_f32_16x16x32_bf16 v[164:167], v[96:99], a[200:203], v[164:167]
    ds_read_b64_tr_b16 v[80:81], v19 offset:16384
    ds_read_b64_tr_b16 v[82:83], v19 offset:16896
    buffer_load_dwordx4 a[232:235], v1, s[28:31], s48 offen offset:2048 sc1
    v_mfma_f32_16x16x32_bf16 v[168:171], v[100:103], a[200:203], v[168:171]
    ds_read_b64_tr_b16 v[84:85], v20 offset:16384
    ds_read_b64_tr_b16 v[86:87], v20 offset:16896
    v_mfma_f32_16x16x32_bf16 v[172:175], v[104:107], a[200:203], v[172:175]
    ds_read_b64_tr_b16 v[88:89], v21 offset:16384
    ds_read_b64_tr_b16 v[90:91], v21 offset:16896
    v_mfma_f32_16x16x32_bf16 v[176:179], v[108:111], a[200:203], v[176:179]
    ds_read_b64_tr_b16 v[92:93], v22 offset:16384
    ds_read_b64_tr_b16 v[94:95], v22 offset:16896
    s_waitcnt vmcnt(7) lgkmcnt(8)
    v_mfma_f32_16x16x32_bf16 v[164:167], v[64:67], a[204:207], v[164:167]
    ds_read_b64_tr_b16 v[96:97], v19 offset:20480
    ds_read_b64_tr_b16 v[98:99], v19 offset:20992
    buffer_load_dwordx4 a[236:239], v1, s[28:31], s48 offen offset:3072 sc1
    v_mfma_f32_16x16x32_bf16 v[168:171], v[68:71], a[204:207], v[168:171]
    ds_read_b64_tr_b16 v[100:101], v20 offset:20480
    ds_read_b64_tr_b16 v[102:103], v20 offset:20992
    v_mfma_f32_16x16x32_bf16 v[172:175], v[72:75], a[204:207], v[172:175]
    ds_read_b64_tr_b16 v[104:105], v21 offset:20480
    ds_read_b64_tr_b16 v[106:107], v21 offset:20992
    v_mfma_f32_16x16x32_bf16 v[176:179], v[76:79], a[204:207], v[176:179]
    ds_read_b64_tr_b16 v[108:109], v22 offset:20480
    ds_read_b64_tr_b16 v[110:111], v22 offset:20992
    s_waitcnt vmcnt(7) lgkmcnt(8)
    v_mfma_f32_16x16x32_bf16 v[164:167], v[80:83], a[208:211], v[164:167]
    ds_read_b64_tr_b16 v[64:65], v19 offset:24576
    ds_read_b64_tr_b16 v[66:67], v19 offset:25088
    s_add_u32 s48, s54, 12288
    buffer_load_dwordx4 a[240:243], v1, s[28:31], s48 offen offset:0 sc1
    v_mfma_f32_16x16x32_bf16 v[168:171], v[84:87], a[208:211], v[168:171]
    ds_read_b64_tr_b16 v[68:69], v20 offset:24576
    ds_read_b64_tr_b16 v[70:71], v20 offset:25088
    v_mfma_f32_16x16x32_bf16 v[172:175], v[88:91], a[208:211], v[172:175]
    ds_read_b64_tr_b16 v[72:73], v21 offset:24576
    ds_read_b64_tr_b16 v[74:75], v21 offset:25088
    v_mfma_f32_16x16x32_bf16 v[176:179], v[92:95], a[208:211], v[176:179]
    ds_read_b64_tr_b16 v[76:77], v22 offset:24576
    ds_read_b64_tr_b16 v[78:79], v22 offset:25088
    s_waitcnt vmcnt(7) lgkmcnt(8)
    v_mfma_f32_16x16x32_bf16 v[164:167], v[96:99], a[212:215], v[164:167]
    ds_read_b64_tr_b16 v[80:81], v19 offset:28672
    ds_read_b64_tr_b16 v[82:83], v19 offset:29184
    buffer_load_dwordx4 a[244:247], v1, s[28:31], s48 offen offset:1024 sc1
    v_mfma_f32_16x16x32_bf16 v[168:171], v[100:103], a[212:215], v[168:171]
    ds_read_b64_tr_b16 v[84:85], v20 offset:28672
    ds_read_b64_tr_b16 v[86:87], v20 offset:29184
    v_mfma_f32_16x16x32_bf16 v[172:175], v[104:107], a[212:215], v[172:175]
    ds_read_b64_tr_b16 v[88:89], v21 offset:28672
    ds_read_b64_tr_b16 v[90:91], v21 offset:29184
    s_add_u32 s49, s63, 704512
    s_add_u32 m0, s62, 0
    s_nop 0
    buffer_load_dwordx4 v8, s[16:19], s49 offen lds
    v_mfma_f32_16x16x32_bf16 v[176:179], v[108:111], a[212:215], v[176:179]
    ds_read_b64_tr_b16 v[92:93], v22 offset:28672
    ds_read_b64_tr_b16 v[94:95], v22 offset:29184
    s_waitcnt vmcnt(8) lgkmcnt(8)
    v_mfma_f32_16x16x32_bf16 v[164:167], v[64:67], a[216:219], v[164:167]
    ds_read_b64_tr_b16 v[96:97], v19 offset:32768
    ds_read_b64_tr_b16 v[98:99], v19 offset:33280
    buffer_load_dwordx4 a[248:251], v1, s[28:31], s48 offen offset:2048 sc1
    v_mfma_f32_16x16x32_bf16 v[168:171], v[68:71], a[216:219], v[168:171]
    ds_read_b64_tr_b16 v[100:101], v20 offset:32768
    ds_read_b64_tr_b16 v[102:103], v20 offset:33280
    v_mfma_f32_16x16x32_bf16 v[172:175], v[72:75], a[216:219], v[172:175]
    ds_read_b64_tr_b16 v[104:105], v21 offset:32768
    ds_read_b64_tr_b16 v[106:107], v21 offset:33280
    buffer_load_dwordx4 v9, s[16:19], s49 offen offset:1024 lds
    v_mfma_f32_16x16x32_bf16 v[176:179], v[76:79], a[216:219], v[176:179]
    ds_read_b64_tr_b16 v[108:109], v22 offset:32768
    ds_read_b64_tr_b16 v[110:111], v22 offset:33280
    s_waitcnt vmcnt(9) lgkmcnt(8)
    v_mfma_f32_16x16x32_bf16 v[164:167], v[80:83], a[220:223], v[164:167]
    ds_read_b64_tr_b16 v[64:65], v19 offset:36864
    ds_read_b64_tr_b16 v[66:67], v19 offset:37376
    buffer_load_dwordx4 a[252:255], v1, s[28:31], s48 offen offset:3072 sc1
    v_mfma_f32_16x16x32_bf16 v[168:171], v[84:87], a[220:223], v[168:171]
    ds_read_b64_tr_b16 v[68:69], v20 offset:36864
    ds_read_b64_tr_b16 v[70:71], v20 offset:37376
    v_mfma_f32_16x16x32_bf16 v[172:175], v[88:91], a[220:223], v[172:175]
    ds_read_b64_tr_b16 v[72:73], v21 offset:36864
    ds_read_b64_tr_b16 v[74:75], v21 offset:37376
    buffer_load_dwordx4 v10, s[16:19], s49 offen offset:2048 lds
    v_mfma_f32_16x16x32_bf16 v[176:179], v[92:95], a[220:223], v[176:179]
    ds_read_b64_tr_b16 v[76:77], v22 offset:36864
    ds_read_b64_tr_b16 v[78:79], v22 offset:37376
    s_waitcnt vmcnt(10) lgkmcnt(8)
    v_mfma_f32_16x16x32_bf16 v[164:167], v[96:99], a[224:227], v[164:167]
    ds_read_b64_tr_b16 v[80:81], v19 offset:40960
    ds_read_b64_tr_b16 v[82:83], v19 offset:41472
    v_mfma_f32_16x16x32_bf16 v[168:171], v[100:103], a[224:227], v[168:171]
    ds_read_b64_tr_b16 v[84:85], v20 offset:40960
    ds_read_b64_tr_b16 v[86:87], v20 offset:41472
    v_mfma_f32_16x16x32_bf16 v[172:175], v[104:107], a[224:227], v[172:175]
    ds_read_b64_tr_b16 v[88:89], v21 offset:40960
    ds_read_b64_tr_b16 v[90:91], v21 offset:41472
    buffer_load_dwordx4 v11, s[16:19], s49 offen offset:3072 lds
    v_mfma_f32_16x16x32_bf16 v[176:179], v[108:111], a[224:227], v[176:179]
    ds_read_b64_tr_b16 v[92:93], v22 offset:40960
    ds_read_b64_tr_b16 v[94:95], v22 offset:41472
    s_waitcnt vmcnt(10) lgkmcnt(8)
    v_mfma_f32_16x16x32_bf16 v[164:167], v[64:67], a[228:231], v[164:167]
    ds_read_b64_tr_b16 v[96:97], v19 offset:45056
    ds_read_b64_tr_b16 v[98:99], v19 offset:45568
    v_mfma_f32_16x16x32_bf16 v[168:171], v[68:71], a[228:231], v[168:171]
    ds_read_b64_tr_b16 v[100:101], v20 offset:45056
    ds_read_b64_tr_b16 v[102:103], v20 offset:45568
    v_mfma_f32_16x16x32_bf16 v[172:175], v[72:75], a[228:231], v[172:175]
    ds_read_b64_tr_b16 v[104:105], v21 offset:45056
    ds_read_b64_tr_b16 v[106:107], v21 offset:45568
    s_add_u32 m0, s62, 4096
    s_nop 0
    buffer_load_dwordx4 v12, s[16:19], s49 offen lds
    v_mfma_f32_16x16x32_bf16 v[176:179], v[76:79], a[228:231], v[176:179]
    ds_read_b64_tr_b16 v[108:109], v22 offset:45056
    ds_read_b64_tr_b16 v[110:111], v22 offset:45568
    s_waitcnt vmcnt(10) lgkmcnt(8)
    v_mfma_f32_16x16x32_bf16 v[164:167], v[80:83], a[232:235], v[164:167]
    ds_read_b64_tr_b16 v[64:65], v19 offset:49152
    ds_read_b64_tr_b16 v[66:67], v19 offset:49664
    v_mfma_f32_16x16x32_bf16 v[168:171], v[84:87], a[232:235], v[168:171]
    ds_read_b64_tr_b16 v[68:69], v20 offset:49152
    ds_read_b64_tr_b16 v[70:71], v20 offset:49664
    v_mfma_f32_16x16x32_bf16 v[172:175], v[88:91], a[232:235], v[172:175]
    ds_read_b64_tr_b16 v[72:73], v21 offset:49152
    ds_read_b64_tr_b16 v[74:75], v21 offset:49664
    buffer_load_dwordx4 v13, s[16:19], s49 offen offset:1024 lds
    v_mfma_f32_16x16x32_bf16 v[176:179], v[92:95], a[232:235], v[176:179]
    ds_read_b64_tr_b16 v[76:77], v22 offset:49152
    ds_read_b64_tr_b16 v[78:79], v22 offset:49664
    s_waitcnt vmcnt(10) lgkmcnt(8)
    v_mfma_f32_16x16x32_bf16 v[164:167], v[96:99], a[236:239], v[164:167]
    ds_read_b64_tr_b16 v[80:81], v19 offset:53248
    ds_read_b64_tr_b16 v[82:83], v19 offset:53760
    v_mfma_f32_16x16x32_bf16 v[168:171], v[100:103], a[236:239], v[168:171]
    ds_read_b64_tr_b16 v[84:85], v20 offset:53248
    ds_read_b64_tr_b16 v[86:87], v20 offset:53760
    v_mfma_f32_16x16x32_bf16 v[172:175], v[104:107], a[236:239], v[172:175]
    ds_read_b64_tr_b16 v[88:89], v21 offset:53248
    ds_read_b64_tr_b16 v[90:91], v21 offset:53760
    buffer_load_dwordx4 v14, s[16:19], s49 offen offset:2048 lds
    v_mfma_f32_16x16x32_bf16 v[176:179], v[108:111], a[236:239], v[176:179]
    ds_read_b64_tr_b16 v[92:93], v22 offset:53248
    ds_read_b64_tr_b16 v[94:95], v22 offset:53760
    s_waitcnt vmcnt(10) lgkmcnt(8)
    v_mfma_f32_16x16x32_bf16 v[164:167], v[64:67], a[240:243], v[164:167]
    ds_read_b64_tr_b16 v[96:97], v19 offset:57344
    ds_read_b64_tr_b16 v[98:99], v19 offset:57856
    v_mfma_f32_16x16x32_bf16 v[168:171], v[68:71], a[240:243], v[168:171]
    ds_read_b64_tr_b16 v[100:101], v20 offset:57344
    ds_read_b64_tr_b16 v[102:103], v20 offset:57856
    v_mfma_f32_16x16x32_bf16 v[172:175], v[72:75], a[240:243], v[172:175]
    ds_read_b64_tr_b16 v[104:105], v21 offset:57344
    ds_read_b64_tr_b16 v[106:107], v21 offset:57856
    buffer_load_dwordx4 v15, s[16:19], s49 offen offset:3072 lds
    v_mfma_f32_16x16x32_bf16 v[176:179], v[76:79], a[240:243], v[176:179]
    ds_read_b64_tr_b16 v[108:109], v22 offset:57344
    ds_read_b64_tr_b16 v[110:111], v22 offset:57856
    s_waitcnt vmcnt(10) lgkmcnt(8)
    v_mfma_f32_16x16x32_bf16 v[164:167], v[80:83], a[244:247], v[164:167]
    ds_read_b64_tr_b16 v[64:65], v19 offset:61440
    ds_read_b64_tr_b16 v[66:67], v19 offset:61952
    v_mfma_f32_16x16x32_bf16 v[168:171], v[84:87], a[244:247], v[168:171]
    ds_read_b64_tr_b16 v[68:69], v20 offset:61440
    ds_read_b64_tr_b16 v[70:71], v20 offset:61952
    v_mfma_f32_16x16x32_bf16 v[172:175], v[88:91], a[244:247], v[172:175]
    ds_read_b64_tr_b16 v[72:73], v21 offset:61440
    ds_read_b64_tr_b16 v[74:75], v21 offset:61952
    s_add_u32 m0, s62, 8192
    s_nop 0
    buffer_load_dwordx4 v16, s[16:19], s49 offen lds
    v_mfma_f32_16x16x32_bf16 v[176:179], v[92:95], a[244:247], v[176:179]
    ds_read_b64_tr_b16 v[76:77], v22 offset:61440
    ds_read_b64_tr_b16 v[78:79], v22 offset:61952
    s_waitcnt vmcnt(9) lgkmcnt(8)
    v_mfma_f32_16x16x32_bf16 v[164:167], v[96:99], a[248:251], v[164:167]
    v_mfma_f32_16x16x32_bf16 v[168:171], v[100:103], a[248:251], v[168:171]
    v_mfma_f32_16x16x32_bf16 v[172:175], v[104:107], a[248:251], v[172:175]
    buffer_load_dwordx4 v17, s[16:19], s49 offen offset:1024 lds
    v_mfma_f32_16x16x32_bf16 v[176:179], v[108:111], a[248:251], v[176:179]
    s_waitcnt vmcnt(8) lgkmcnt(0)
    v_mfma_f32_16x16x32_bf16 v[164:167], v[64:67], a[252:255], v[164:167]
    v_mfma_f32_16x16x32_bf16 v[168:171], v[68:71], a[252:255], v[168:171]
    v_mfma_f32_16x16x32_bf16 v[172:175], v[72:75], a[252:255], v[172:175]
    buffer_load_dwordx4 v18, s[16:19], s49 offen offset:2048 lds
    v_mfma_f32_16x16x32_bf16 v[176:179], v[76:79], a[252:255], v[176:179]
    s_nop 3
    v_cvt_pk_bf16_f32 v140, v164, v165
    v_cvt_pk_bf16_f32 v141, v166, v167
    v_cvt_pk_bf16_f32 v142, v168, v169
    v_cvt_pk_bf16_f32 v143, v170, v171
    v_cvt_pk_bf16_f32 v144, v172, v173
    v_cvt_pk_bf16_f32 v145, v174, v175
    v_cvt_pk_bf16_f32 v146, v176, v177
    v_cvt_pk_bf16_f32 v147, v178, v179
    v_mfma_f32_16x16x32_bf16 v[112:115], v[160:163], v[140:143], 0
    v_mfma_f32_16x16x32_bf16 v[116:119], v[140:143], v[140:143], 0
    v_mfma_f32_16x16x32_bf16 v[112:115], v[160:163], v[144:147], v[112:115]
    v_mfma_f32_16x16x32_bf16 v[116:119], v[144:147], v[144:147], v[116:119]
    buffer_store_dwordx4 v[140:143], v1, s[28:31], s55 offen sc1
    buffer_store_dwordx4 v[144:147], v1, s[28:31], s55 offen offset:1024 sc1
    s_nop 5
    v_cndmask_b32_e64 v113, v116, v117, s[84:85]
    v_cndmask_b32_e64 v113, v113, v118, s[86:87]
    v_cndmask_b32_e64 v113, v113, v119, s[88:89]
    buffer_store_dwordx2 v[112:113], v27, s[28:31], s56 offen sc1
    s_add_u32 s49, s63, s3
    s_add_u32 s49, s49, 704512
    s_add_u32 m0, s62, 45056
    s_nop 0
    buffer_load_dwordx4 v8, s[16:19], s49 offen lds
    buffer_load_dwordx4 v9, s[16:19], s49 offen offset:1024 lds
    buffer_load_dwordx4 v10, s[16:19], s49 offen offset:2048 lds
    buffer_load_dwordx4 v11, s[16:19], s49 offen offset:3072 lds
    s_add_u32 m0, s62, 49152
    s_nop 0
    buffer_load_dwordx4 v12, s[16:19], s49 offen lds
    s_waitcnt vmcnt(5)
    v_mov_b32 v62, 2
    s_cmp_eq_u32 s47, 1
    s_cbranch_scc0 L_pub_slow2
    buffer_store_dword v62, v29, s[28:31], 0 offen
L_pub_done2:
    buffer_load_dwordx4 v13, s[16:19], s49 offen offset:1024 lds
    buffer_load_dwordx4 v14, s[16:19], s49 offen offset:2048 lds
    buffer_load_dwordx4 v15, s[16:19], s49 offen offset:3072 lds
    s_add_u32 m0, s62, 53248
    s_nop 0
    buffer_load_dwordx4 v16, s[16:19], s49 offen lds
    buffer_load_dwordx4 v17, s[16:19], s49 offen offset:1024 lds
    buffer_load_dwordx4 v18, s[16:19], s49 offen offset:2048 lds
    s_barrier
    ds_read_b64_tr_b16 a[96:97], v23 offset:0
    ds_read_b64_tr_b16 a[98:99], v23 offset:5632
    ds_read_b64_tr_b16 a[100:101], v23 offset:32
    ds_read_b64_tr_b16 a[102:103], v23 offset:5664
    ds_read_b64_tr_b16 a[104:105], v23 offset:64
    ds_read_b64_tr_b16 a[106:107], v23 offset:5696
    ds_read_b64_tr_b16 a[108:109], v23 offset:11264
    ds_read_b64_tr_b16 a[110:111], v23 offset:16896
    ds_read_b64_tr_b16 a[112:113], v23 offset:11296
    ds_read_b64_tr_b16 a[114:115], v23 offset:16928
    ds_read_b64_tr_b16 a[116:117], v23 offset:11328
    ds_read_b64_tr_b16 a[118:119], v23 offset:16960
    s_waitcnt lgkmcnt(6)
    v_mfma_f32_16x16x32_bf16 v[148:151], a[96:99], v[160:163], v[148:151]
    ds_read_b64_tr_b16 a[120:121], v23 offset:22528
    ds_read_b64_tr_b16 a[122:123], v23 offset:28160
    v_mfma_f32_16x16x32_bf16 v[152:155], a[100:103], v[160:163], v[152:155]
    ds_read_b64_tr_b16 a[124:125], v23 offset:22560
    ds_read_b64_tr_b16 a[126:127], v23 offset:28192
    v_mfma_f32_16x16x32_bf16 v[156:159], a[104:107], v[160:163], v[156:159]
    ds_read_b64_tr_b16 a[128:129], v23 offset:22592
    ds_read_b64_tr_b16 a[130:131], v23 offset:28224
    s_waitcnt lgkmcnt(6)
    v_mfma_f32_16x16x32_bf16 v[148:151], a[108:111], v[160:163], v[148:151]
    ds_read_b64_tr_b16 a[132:133], v23 offset:33792
    ds_read_b64_tr_b16 a[134:135], v23 offset:39424
    v_mfma_f32_16x16x32_bf16 v[152:155], a[112:115], v[160:163], v[152:155]
    ds_read_b64_tr_b16 a[136:137], v23 offset:33824
    ds_read_b64_tr_b16 a[138:139], v23 offset:39456
    v_mfma_f32_16x16x32_bf16 v[156:159], a[116:119], v[160:163], v[156:159]
    ds_read_b64_tr_b16 a[140:141], v23 offset:33856
    ds_read_b64_tr_b16 a[142:143], v23 offset:39488
    s_waitcnt lgkmcnt(6)
    v_mfma_f32_16x16x32_bf16 v[148:151], a[120:123], v[160:163], v[148:151]
    v_mfma_f32_16x16x32_bf16 v[152:155], a[124:127], v[160:163], v[152:155]
    v_mfma_f32_16x16x32_bf16 v[156:159], a[128:131], v[160:163], v[156:159]
    s_waitcnt lgkmcnt(0)
    v_mfma_f32_16x16x32_bf16 v[148:151], a[132:135], v[160:163], v[148:151]
    v_mfma_f32_16x16x32_bf16 v[152:155], a[136:139], v[160:163], v[152:155]
    v_mfma_f32_16x16x32_bf16 v[156:159], a[140:143], v[160:163], v[156:159]
    s_mov_b32 s53, 0
    buffer_load_dword v63, v30, s[28:31], 0 offen sc1
L_poll2:
    buffer_load_dword v60, v30, s[28:31], 0 offen sc1
    s_waitcnt vmcnt(1)
    v_cmp_le_u32 vcc, 2, v63
    s_nop 0
    s_cmp_eq_u64 vcc, -1
    s_cbranch_scc1 L_poll_ok2
    buffer_load_dword v63, v30, s[28:31], 0 offen sc1
    s_waitcnt vmcnt(1)
    v_cmp_le_u32 vcc, 2, v60
    s_nop 0
    s_cmp_eq_u64 vcc, -1
    s_cbranch_scc1 L_poll_ok2
    s_add_u32 s53, s53, 1
    s_cmp_lt_u32 s53, 0x20000
    s_cbranch_scc1 L_poll2
    s_branch L_end
L_poll_ok2:
    s_cmp_eq_u32 s47, 1
    s_cbranch_scc0 L_acq_slow2
L_acq_done2:
    buffer_load_dwordx2 v[64:65], v28, s[28:31], s99 offen sc1
    buffer_load_dwordx2 v[66:67], v28, s[28:31], s99 offen offset:128 sc1
    s_mov_b32 m0, s52
    s_add_u32 s48, s57, 0
    buffer_load_dwordx4 v1, s[28:31], s48 offen sc1 lds
    buffer_load_dwordx4 v1, s[28:31], s48 offen offset:1024 sc1 lds
    buffer_load_dwordx4 v1, s[28:31], s48 offen offset:2048 sc1 lds
    buffer_load_dwordx4 v1, s[28:31], s48 offen offset:3072 sc1 lds
    s_add_u32 m0, s52, 16384
    s_add_u32 s48, s57, 16384
    buffer_load_dwordx4 v1, s[28:31], s48 offen sc1 lds
    buffer_load_dwordx4 v1, s[28:31], s48 offen offset:1024 sc1 lds
    buffer_load_dwordx4 v1, s[28:31], s48 offen offset:2048 sc1 lds
    buffer_load_dwordx4 v1, s[28:31], s48 offen offset:3072 sc1 lds
    s_barrier
    ds_read_b64_tr_b16 a[144:145], v24 offset:0
    ds_read_b64_tr_b16 a[146:147], v24 offset:5632
    ds_read_b64_tr_b16 a[148:149], v24 offset:32
    ds_read_b64_tr_b16 a[150:151], v24 offset:5664
    ds_read_b64_tr_b16 a[152:153], v24 offset:64
    ds_read_b64_tr_b16 a[154:155], v24 offset:5696
    ds_read_b64_tr_b16 a[156:157], v24 offset:11264
    ds_read_b64_tr_b16 a[158:159], v24 offset:16896
    ds_read_b64_tr_b16 a[160:161], v24 offset:11296
    ds_read_b64_tr_b16 a[162:163], v24 offset:16928
    ds_read_b64_tr_b16 a[164:165], v24 offset:11328
    ds_read_b64_tr_b16 a[166:167], v24 offset:16960
    s_waitcnt lgkmcnt(6)
    v_mfma_f32_16x16x32_bf16 v[148:151], a[144:147], v[160:163], v[148:151]
    ds_read_b64_tr_b16 a[168:169], v24 offset:22528
    ds_read_b64_tr_b16 a[170:171], v24 offset:28160
    v_mfma_f32_16x16x32_bf16 v[152:155], a[148:151], v[160:163], v[152:155]
    ds_read_b64_tr_b16 a[172:173], v24 offset:22560
    ds_read_b64_tr_b16 a[174:175], v24 offset:28192
    v_mfma_f32_16x16x32_bf16 v[156:159], a[152:155], v[160:163], v[156:159]
    ds_read_b64_tr_b16 a[176:177], v24 offset:22592
    ds_read_b64_tr_b16 a[178:179], v24 offset:28224
    s_waitcnt lgkmcnt(6)
    v_mfma_f32_16x16x32_bf16 v[148:151], a[156:159], v[160:163], v[148:151]
    ds_read_b64_tr_b16 a[180:181], v24 offset:33792
    ds_read_b64_tr_b16 a[182:183], v24 offset:39424
    v_mfma_f32_16x16x32_bf16 v[152:155], a[160:163], v[160:163], v[152:155]
    ds_read_b64_tr_b16 a[184:185], v24 offset:33824
    ds_read_b64_tr_b16 a[186:187], v24 offset:39456
    v_mfma_f32_16x16x32_bf16 v[156:159], a[164:167], v[160:163], v[156:159]
    ds_read_b64_tr_b16 a[188:189], v24 offset:33856
    ds_read_b64_tr_b16 a[190:191], v24 offset:39488
    s_waitcnt lgkmcnt(6)
    v_mfma_f32_16x16x32_bf16 v[148:151], a[168:171], v[160:163], v[148:151]
    v_mfma_f32_16x16x32_bf16 v[152:155], a[172:175], v[160:163], v[152:155]
    v_mfma_f32_16x16x32_bf16 v[156:159], a[176:179], v[160:163], v[156:159]
    s_waitcnt lgkmcnt(0)
    v_mfma_f32_16x16x32_bf16 v[148:151], a[180:183], v[160:163], v[148:151]
    v_mfma_f32_16x16x32_bf16 v[152:155], a[184:187], v[160:163], v[152:155]
    v_mfma_f32_16x16x32_bf16 v[156:159], a[188:191], v[160:163], v[156:159]
    s_waitcnt vmcnt(8)
    v_add_f32 v64, v64, v66
    v_add_f32 v65, v65, v67
    v_mov_b32 v66, v64
    v_mov_b32 v67, v65
    s_nop 0
    v_permlane16_swap_b32 v64, v66
    v_permlane16_swap_b32 v65, v67
    v_add_f32 v64, v64, v66
    v_add_f32 v65, v65, v67
    v_mov_b32 v66, v64
    v_mov_b32 v67, v65
    s_nop 0
    v_permlane32_swap_b32 v64, v66
    v_permlane32_swap_b32 v65, v67
    v_add_f32 v64, v64, v66
    v_add_f32 v65, v65, v67
    v_mul_f32 v68, s95, v64
    v_fma_f32 v66, v68, v68, -s96
    v_fma_f32 v66, v65, s94, -v66
    v_max_f32 v66, s96, v66
    v_rsq_f32 v69, v66
    v_lshlrev_b32 v70, 3, v2
    s_lshl_b32 s40, s46, 7
    s_add_u32 s40, s40, 156672
    v_add_u32 v71, s40, v70
    ds_write_b64 v71, v[68:69]
    v_add_u32 v70, 156672, v70
    s_waitcnt vmcnt(4) lgkmcnt(0)
    s_barrier
    ds_read_b64 v[164:165], v70 offset:0
    ds_read_b64 v[166:167], v70 offset:128
    ds_read_b64 v[168:169], v70 offset:256
    ds_read_b64 v[170:171], v70 offset:384
    s_waitcnt lgkmcnt(0)
    v_mul_f32 v172, s98, v165
    v_mul_f32 v174, s98, v167
    v_mul_f32 v176, s98, v169
    v_mul_f32 v178, s98, v171
    ds_read_b128 a[192:195], v1 offset:0
    ds_read_b128 a[196:199], v1 offset:1024
    ds_read_b128 a[200:203], v1 offset:2048
    ds_read_b128 a[204:207], v1 offset:3072
    s_waitcnt lgkmcnt(2)
    v_mfma_f32_16x16x32_bf16 v[64:67], a[0:3], a[192:195], 0
    s_add_u32 m0, s52, 32768
    s_add_u32 s48, s57, 32768
    v_mfma_f32_16x16x32_bf16 v[68:71], a[4:7], a[192:195], 0
    buffer_load_dwordx4 v1, s[28:31], s48 offen sc1 lds
    v_mfma_f32_16x16x32_bf16 v[72:75], a[8:11], a[192:195], 0
    ds_read_b128 a[208:211], v1 offset:4096
    v_mfma_f32_16x16x32_bf16 v[64:67], a[12:15], a[196:199], v[64:67]
    ds_read_b128 a[212:215], v1 offset:5120
    v_mfma_f32_16x16x32_bf16 v[68:71], a[16:19], a[196:199], v[68:71]
    buffer_load_dwordx4 v1, s[28:31], s48 offen offset:1024 sc1 lds
    v_mfma_f32_16x16x32_bf16 v[72:75], a[20:23], a[196:199], v[72:75]
    s_waitcnt lgkmcnt(2)
    v_mfma_f32_16x16x32_bf16 v[64:67], a[24:27], a[200:203], v[64:67]
    ds_read_b128 a[216:219], v1 offset:6144
    v_mfma_f32_16x16x32_bf16 v[68:71], a[28:31], a[200:203], v[68:71]
    ds_read_b128 a[220:223], v1 offset:7168
    v_mfma_f32_16x16x32_bf16 v[72:75], a[32:35], a[200:203], v[72:75]
    buffer_load_dwordx4 v1, s[28:31], s48 offen offset:2048 sc1 lds
    v_mfma_f32_16x16x32_bf16 v[64:67], a[36:39], a[204:207], v[64:67]
    v_mfma_f32_16x16x32_bf16 v[68:71], a[40:43], a[204:207], v[68:71]
    v_mfma_f32_16x16x32_bf16 v[72:75], a[44:47], a[204:207], v[72:75]
    s_waitcnt lgkmcnt(2)
    v_mfma_f32_16x16x32_bf16 v[64:67], a[48:51], a[208:211], v[64:67]
    buffer_load_dwordx4 v1, s[28:31], s48 offen offset:3072 sc1 lds
    v_mfma_f32_16x16x32_bf16 v[68:71], a[52:55], a[208:211], v[68:71]
    ds_read_b128 a[192:195], v1 offset:8192
    ds_read_b128 a[196:199], v1 offset:9216
    v_mfma_f32_16x16x32_bf16 v[72:75], a[56:59], a[208:211], v[72:75]
    s_lshr_b32 s40, s1, 5
    s_mul_i32 s40, s40, 360448
    v_mfma_f32_16x16x32_bf16 v[64:67], a[60:63], a[212:215], v[64:67]
    s_and_b32 s41, s1, 31
    s_mul_i32 s41, s41, 3072
    s_add_u32 s40, s40, s41
    v_lshl_add_u32 v124, v0, 7, s40
    v_mov_b32 v119, 0x80000000
    v_cmp_gt_u32 vcc, 24, v0
    s_nop 1
    v_cndmask_b32 v124, v119, v124, vcc
    s_mov_b32 s42, 0
    v_mfma_f32_16x16x32_bf16 v[68:71], a[64:67], a[212:215], v[68:71]
    buffer_load_dword v238, v124, s[20:23], s42 offen sc1
    v_mfma_f32_16x16x32_bf16 v[72:75], a[68:71], a[212:215], v[72:75]
    s_waitcnt lgkmcnt(2)
    v_mfma_f32_16x16x32_bf16 v[64:67], a[72:75], a[216:219], v[64:67]
    ds_read_b128 a[200:203], v1 offset:10240
    v_mfma_f32_16x16x32_bf16 v[68:71], a[76:79], a[216:219], v[68:71]
    ds_read_b128 a[204:207], v1 offset:11264
    v_mfma_f32_16x16x32_bf16 v[72:75], a[80:83], a[216:219], v[72:75]
    v_mfma_f32_16x16x32_bf16 v[64:67], a[84:87], a[220:223], v[64:67]
    s_add_u32 m0, s52, 65536
    s_add_u32 s49, s61, 0
    v_mfma_f32_16x16x32_bf16 v[68:71], a[88:91], a[220:223], v[68:71]
    buffer_load_dwordx4 v4, s[20:23], s49 offen lds
    v_mfma_f32_16x16x32_bf16 v[72:75], a[92:95], a[220:223], v[72:75]
    s_waitcnt lgkmcnt(2)
    v_mfma_f32_16x16x32_bf16 v[64:67], a[96:99], a[192:195], v[64:67]
    ds_read_b128 a[208:211], v1 offset:12288
    v_mfma_f32_16x16x32_bf16 v[68:71], a[100:103], a[192:195], v[68:71]
    ds_read_b128 a[212:215], v1 offset:13312
    v_mfma_f32_16x16x32_bf16 v[72:75], a[104:107], a[192:195], v[72:75]
    v_mfma_f32_16x16x32_bf16 v[64:67], a[108:111], a[196:199], v[64:67]
    buffer_load_dwordx4 v5, s[20:23], s49 offen offset:1024 lds
    v_mfma_f32_16x16x32_bf16 v[68:71], a[112:115], a[196:199], v[68:71]
    v_mfma_f32_16x16x32_bf16 v[72:75], a[116:119], a[196:199], v[72:75]
    s_waitcnt lgkmcnt(2)
    v_mfma_f32_16x16x32_bf16 v[64:67], a[120:123], a[200:203], v[64:67]
    ds_read_b128 a[216:219], v1 offset:14336
    v_mfma_f32_16x16x32_bf16 v[68:71], a[124:127], a[200:203], v[68:71]
    ds_read_b128 a[220:223], v1 offset:15360
    v_mfma_f32_16x16x32_bf16 v[72:75], a[128:131], a[200:203], v[72:75]
    buffer_load_dwordx4 v6, s[20:23], s49 offen offset:2048 lds
    v_mfma_f32_16x16x32_bf16 v[64:67], a[132:135], a[204:207], v[64:67]
    v_mfma_f32_16x16x32_bf16 v[68:71], a[136:139], a[204:207], v[68:71]
    v_mfma_f32_16x16x32_bf16 v[72:75], a[140:143], a[204:207], v[72:75]
    s_waitcnt lgkmcnt(2)
    v_mfma_f32_16x16x32_bf16 v[64:67], a[144:147], a[208:211], v[64:67]
    s_waitcnt vmcnt(8)
    s_barrier
    ds_read_b128 a[192:195], v1 offset:16384
    v_mfma_f32_16x16x32_bf16 v[68:71], a[148:151], a[208:211], v[68:71]
    buffer_load_dwordx4 v7, s[20:23], s49 offen offset:3072 lds
    v_mfma_f32_16x16x32_bf16 v[72:75], a[152:155], a[208:211], v[72:75]
    ds_read_b128 a[196:199], v1 offset:17408
    v_mfma_f32_16x16x32_bf16 v[64:67], a[156:159], a[212:215], v[64:67]
    v_mfma_f32_16x16x32_bf16 v[68:71], a[160:163], a[212:215], v[68:71]
    s_mov_b32 s42, 98304
    v_mfma_f32_16x16x32_bf16 v[72:75], a[164:167], a[212:215], v[72:75]
    s_waitcnt lgkmcnt(2)
    v_mfma_f32_16x16x32_bf16 v[64:67], a[168:171], a[216:219], v[64:67]
    buffer_load_dword v238, v124, s[20:23], s42 offen sc1
    v_mfma_f32_16x16x32_bf16 v[68:71], a[172:175], a[216:219], v[68:71]
    ds_read_b128 a[200:203], v1 offset:18432
    ds_read_b128 a[204:207], v1 offset:19456
    v_mfma_f32_16x16x32_bf16 v[72:75], a[176:179], a[216:219], v[72:75]
    v_mfma_f32_16x16x32_bf16 v[64:67], a[180:183], a[220:223], v[64:67]
    v_mfma_f32_16x16x32_bf16 v[68:71], a[184:187], a[220:223], v[68:71]
    v_mfma_f32_16x16x32_bf16 v[72:75], a[188:191], a[220:223], v[72:75]
    s_waitcnt lgkmcnt(2)
    v_mfma_f32_16x16x32_bf16 v[76:79], a[0:3], a[192:195], 0
    s_add_u32 m0, s52, 49152
    s_add_u32 s48, s57, 49152
    v_mfma_f32_16x16x32_bf16 v[80:83], a[4:7], a[192:195], 0
    buffer_load_dwordx4 v1, s[28:31], s48 offen sc1 lds
    v_mfma_f32_16x16x32_bf16 v[84:87], a[8:11], a[192:195], 0
    v_fmac_f32 v64, v164, v148
    ds_read_b128 a[208:211], v1 offset:20480
    v_fmac_f32 v65, v164, v149
    v_mul_f32 v100, v172, v64
    v_mfma_f32_16x16x32_bf16 v[76:79], a[12:15], a[196:199], v[76:79]
    ds_read_b128 a[212:215], v1 offset:21504
    v_exp_f32 v100, v100
    v_fmac_f32 v66, v164, v150
    v_mul_f32 v101, v172, v65
    v_mfma_f32_16x16x32_bf16 v[80:83], a[16:19], a[196:199], v[80:83]
    buffer_load_dwordx4 v1, s[28:31], s48 offen offset:1024 sc1 lds
    v_mfma_f32_16x16x32_bf16 v[84:87], a[20:23], a[196:199], v[84:87]
    v_exp_f32 v101, v101
    v_mul_f32 v88, v165, v64
    v_fmac_f32 v67, v164, v151
    s_waitcnt lgkmcnt(2)
    v_mfma_f32_16x16x32_bf16 v[76:79], a[24:27], a[200:203], v[76:79]
    v_mul_f32 v102, v172, v66
    v_exp_f32 v102, v102
    v_mul_f32 v89, v165, v65
    v_mfma_f32_16x16x32_bf16 v[80:83], a[28:31], a[200:203], v[80:83]
    buffer_load_dwordx4 v1, s[28:31], s48 offen offset:2048 sc1 lds
    v_mfma_f32_16x16x32_bf16 v[84:87], a[32:35], a[200:203], v[84:87]
    v_fmac_f32 v68, v164, v152
    ds_read_b128 a[216:219], v1 offset:22528
    v_mul_f32 v103, v172, v67
    v_mul_f32 v90, v165, v66
    v_mfma_f32_16x16x32_bf16 v[76:79], a[36:39], a[204:207], v[76:79]
    ds_read_b128 a[220:223], v1 offset:23552
    v_exp_f32 v103, v103
    v_add_f32 v100, 1.0, v100
    v_mfma_f32_16x16x32_bf16 v[80:83], a[40:43], a[204:207], v[80:83]
    buffer_load_dwordx4 v1, s[28:31], s48 offen offset:3072 sc1 lds
    v_mfma_f32_16x16x32_bf16 v[84:87], a[44:47], a[204:207], v[84:87]
    v_rcp_f32 v100, v100
    v_fmac_f32 v69, v164, v153
    v_mul_f32 v104, v172, v68
    v_mul_f32 v91, v165, v67
    s_waitcnt lgkmcnt(2)
    v_mfma_f32_16x16x32_bf16 v[76:79], a[48:51], a[208:211], v[76:79]
    v_exp_f32 v104, v104
    v_add_f32 v101, 1.0, v101
    v_fmac_f32 v70, v164, v154
    v_mfma_f32_16x16x32_bf16 v[80:83], a[52:55], a[208:211], v[80:83]
    v_mul_f32 v105, v172, v69
    ds_read_b128 a[192:195], v1 offset:24576
    v_rcp_f32 v101, v101
    v_mfma_f32_16x16x32_bf16 v[84:87], a[56:59], a[208:211], v[84:87]
    v_mul_f32 v92, v165, v68
    ds_read_b128 a[196:199], v1 offset:25600
    v_add_f32 v102, 1.0, v102
    v_mfma_f32_16x16x32_bf16 v[76:79], a[60:63], a[212:215], v[76:79]
    v_exp_f32 v105, v105
    s_add_u32 m0, s52, 81920
    s_add_u32 s49, s61, 32768
    v_mfma_f32_16x16x32_bf16 v[80:83], a[64:67], a[212:215], v[80:83]
    buffer_load_dwordx4 v4, s[20:23], s49 offen lds
    v_mfma_f32_16x16x32_bf16 v[84:87], a[68:71], a[212:215], v[84:87]
    v_rcp_f32 v102, v102
    v_fmac_f32 v71, v164, v155
    v_mul_f32 v106, v172, v70
    v_mul_f32 v93, v165, v69
    s_waitcnt lgkmcnt(2)
    v_mfma_f32_16x16x32_bf16 v[76:79], a[72:75], a[216:219], v[76:79]
    v_exp_f32 v106, v106
    v_add_f32 v103, 1.0, v103
    v_mul_f32 v88, v88, v100
    v_mfma_f32_16x16x32_bf16 v[80:83], a[76:79], a[216:219], v[80:83]
    buffer_load_dwordx4 v5, s[20:23], s49 offen offset:1024 lds
    v_mfma_f32_16x16x32_bf16 v[84:87], a[80:83], a[216:219], v[84:87]
    v_fmac_f32 v72, v164, v156
    ds_read_b128 a[200:203], v1 offset:26624
    v_rcp_f32 v103, v103
    v_mul_f32 v107, v172, v71
    v_mfma_f32_16x16x32_bf16 v[76:79], a[84:87], a[220:223], v[76:79]
    ds_read_b128 a[204:207], v1 offset:27648
    v_mul_f32 v94, v165, v70
    v_add_f32 v104, 1.0, v104
    v_mfma_f32_16x16x32_bf16 v[80:83], a[88:91], a[220:223], v[80:83]
    buffer_load_dwordx4 v6, s[20:23], s49 offen offset:2048 lds
    v_mfma_f32_16x16x32_bf16 v[84:87], a[92:95], a[220:223], v[84:87]
    v_exp_f32 v107, v107
    v_mul_f32 v89, v89, v101
    v_fmac_f32 v73, v164, v157
    s_waitcnt lgkmcnt(2)
    v_mfma_f32_16x16x32_bf16 v[76:79], a[96:99], a[192:195], v[76:79]
    v_rcp_f32 v104, v104
    v_mul_f32 v108, v172, v72
    v_mul_f32 v95, v165, v71
    v_mfma_f32_16x16x32_bf16 v[80:83], a[100:103], a[192:195], v[80:83]
    v_add_f32 v105, 1.0, v105
    ds_read_b128 a[208:211], v1 offset:28672
    v_mul_f32 v90, v90, v102
    ds_read_b128 a[212:215], v1 offset:29696
    v_mfma_f32_16x16x32_bf16 v[84:87], a[104:107], a[192:195], v[84:87]
    buffer_load_dwordx4 v7, s[20:23], s49 offen offset:3072 lds
    v_mfma_f32_16x16x32_bf16 v[76:79], a[108:111], a[196:199], v[76:79]
    v_exp_f32 v108, v108
    v_fmac_f32 v74, v164, v158
    v_mul_f32 v109, v172, v73
    v_mfma_f32_16x16x32_bf16 v[80:83], a[112:115], a[196:199], v[80:83]
    v_rcp_f32 v105, v105
    s_add_u32 m0, s52, 98304
    s_add_u32 s49, s61, 65536
    v_mul_f32 v96, v165, v72
    v_mfma_f32_16x16x32_bf16 v[84:87], a[116:119], a[196:199], v[84:87]
    buffer_load_dwordx4 v4, s[20:23], s49 offen lds
    s_waitcnt lgkmcnt(2)
    v_mfma_f32_16x16x32_bf16 v[76:79], a[120:123], a[200:203], v[76:79]
    v_exp_f32 v109, v109
    v_add_f32 v106, 1.0, v106
    v_mul_f32 v91, v91, v103
    v_fmac_f32 v75, v164, v159
    v_mfma_f32_16x16x32_bf16 v[80:83], a[124:127], a[200:203], v[80:83]
    v_rcp_f32 v106, v106
    v_mul_f32 v110, v172, v74
    v_mfma_f32_16x16x32_bf16 v[84:87], a[128:131], a[200:203], v[84:87]
    ds_read_b128 a[216:219], v1 offset:30720
    v_mul_f32 v97, v165, v73
    v_add_f32 v107, 1.0, v107
    ds_read_b128 a[220:223], v1 offset:31744
    v_mfma_f32_16x16x32_bf16 v[76:79], a[132:135], a[204:207], v[76:79]
    buffer_load_dwordx4 v5, s[20:23], s49 offen offset:1024 lds
    v_mfma_f32_16x16x32_bf16 v[80:83], a[136:139], a[204:207], v[80:83]
    v_exp_f32 v110, v110
    v_rcp_f32 v107, v107
    v_mul_f32 v92, v92, v104
    v_mul_f32 v111, v172, v75
    v_mfma_f32_16x16x32_bf16 v[84:87], a[140:143], a[204:207], v[84:87]
    v_mul_f32 v98, v165, v74
    v_add_f32 v108, 1.0, v108
    s_waitcnt lgkmcnt(2)
    v_mfma_f32_16x16x32_bf16 v[76:79], a[144:147], a[208:211], v[76:79]
    buffer_load_dwordx4 v6, s[20:23], s49 offen offset:2048 lds
    v_mfma_f32_16x16x32_bf16 v[80:83], a[148:151], a[208:211], v[80:83]
    v_exp_f32 v111, v111
    v_rcp_f32 v108, v108
    v_mul_f32 v93, v93, v105
    v_mul_f32 v99, v165, v75
    v_mfma_f32_16x16x32_bf16 v[84:87], a[152:155], a[208:211], v[84:87]
    s_waitcnt vmcnt(17)
    s_barrier
    ds_read_b128 a[192:195], v1 offset:32768
    v_add_f32 v109, 1.0, v109
    v_mul_f32 v94, v94, v106
    v_mfma_f32_16x16x32_bf16 v[76:79], a[156:159], a[212:215], v[76:79]
    ds_read_b128 a[196:199], v1 offset:33792
    v_rcp_f32 v109, v109
    v_add_f32 v110, 1.0, v110
    v_mfma_f32_16x16x32_bf16 v[80:83], a[160:163], a[212:215], v[80:83]
    buffer_load_dwordx4 v7, s[20:23], s49 offen offset:3072 lds
    v_mfma_f32_16x16x32_bf16 v[84:87], a[164:167], a[212:215], v[84:87]
    v_rcp_f32 v110, v110
    v_mul_f32 v95, v95, v107
    v_add_f32 v111, 1.0, v111
    v_mul_f32 v96, v96, v108
    s_waitcnt lgkmcnt(2)
    v_mfma_f32_16x16x32_bf16 v[76:79], a[168:171], a[216:219], v[76:79]
    v_rcp_f32 v111, v111
    s_mov_b32 s42, 196608
    v_mul_f32 v97, v97, v109
    v_mfma_f32_16x16x32_bf16 v[80:83], a[172:175], a[216:219], v[80:83]
    buffer_load_dword v238, v124, s[20:23], s42 offen sc1
    v_mfma_f32_16x16x32_bf16 v[84:87], a[176:179], a[216:219], v[84:87]
    v_mul_f32 v98, v98, v110
    v_mul_f32 v99, v99, v111
    ds_read_b128 a[200:203], v1 offset:34816
    v_cvt_pk_bf16_f32 v112, v88, v89
    v_cvt_pk_bf16_f32 v113, v90, v91
    v_mfma_f32_16x16x32_bf16 v[76:79], a[180:183], a[220:223], v[76:79]
    ds_read_b128 a[204:207], v1 offset:35840
    v_cvt_pk_bf16_f32 v116, v92, v93
    v_cvt_pk_bf16_f32 v117, v94, v95
    v_mfma_f32_16x16x32_bf16 v[80:83], a[184:187], a[220:223], v[80:83]
    v_cvt_pk_bf16_f32 v120, v96, v97
    v_mfma_f32_16x16x32_bf16 v[84:87], a[188:191], a[220:223], v[84:87]
    v_cvt_pk_bf16_f32 v121, v98, v99
    s_waitcnt lgkmcnt(2)
    v_mfma_f32_16x16x32_bf16 v[64:67], a[0:3], a[192:195], 0
    s_add_u32 m0, s52, 114688
    s_add_u32 s49, s61, 98304
    v_mfma_f32_16x16x32_bf16 v[68:71], a[4:7], a[192:195], 0
    buffer_load_dwordx4 v4, s[20:23], s49 offen lds
    v_mfma_f32_16x16x32_bf16 v[72:75], a[8:11], a[192:195], 0
    v_fmac_f32 v76, v166, v148
    v_fmac_f32 v77, v166, v149
    ds_read_b128 a[208:211], v1 offset:36864
    v_mul_f32 v100, v174, v76
    v_exp_f32 v100, v100
    v_fmac_f32 v78, v166, v150
    v_mfma_f32_16x16x32_bf16 v[64:67], a[12:15], a[196:199], v[64:67]
    ds_read_b128 a[212:215], v1 offset:37888
    v_mul_f32 v101, v174, v77
    v_exp_f32 v101, v101
    v_mul_f32 v88, v167, v76
    v_mfma_f32_16x16x32_bf16 v[68:71], a[16:19], a[196:199], v[68:71]
    v_fmac_f32 v79, v166, v151
    v_mul_f32 v102, v174, v78
    v_mfma_f32_16x16x32_bf16 v[72:75], a[20:23], a[196:199], v[72:75]
    buffer_load_dwordx4 v5, s[20:23], s49 offen offset:1024 lds
    s_waitcnt lgkmcnt(2)
    v_mfma_f32_16x16x32_bf16 v[64:67], a[24:27], a[200:203], v[64:67]
    v_exp_f32 v102, v102
    v_mul_f32 v89, v167, v77
    v_fmac_f32 v80, v166, v152
    v_mul_f32 v103, v174, v79
    v_mul_f32 v90, v167, v78
    v_add_f32 v100, 1.0, v100
    v_mfma_f32_16x16x32_bf16 v[68:71], a[28:31], a[200:203], v[68:71]
    v_exp_f32 v103, v103
    v_fmac_f32 v81, v166, v153
    v_mul_f32 v104, v174, v80
    v_mfma_f32_16x16x32_bf16 v[72:75], a[32:35], a[200:203], v[72:75]
    ds_read_b128 a[216:219], v1 offset:38912
    v_rcp_f32 v100, v100
    v_mul_f32 v91, v167, v79
    v_mfma_f32_16x16x32_bf16 v[64:67], a[36:39], a[204:207], v[64:67]
    buffer_load_dwordx4 v6, s[20:23], s49 offen offset:2048 lds
    v_mfma_f32_16x16x32_bf16 v[68:71], a[40:43], a[204:207], v[68:71]
    ds_read_b128 a[220:223], v1 offset:39936
    v_exp_f32 v104, v104
    v_add_f32 v101, 1.0, v101
    v_rcp_f32 v101, v101
    v_fmac_f32 v82, v166, v154
    v_mul_f32 v105, v174, v81
    v_mul_f32 v92, v167, v80
    v_mfma_f32_16x16x32_bf16 v[72:75], a[44:47], a[204:207], v[72:75]
    v_exp_f32 v105, v105
    v_add_f32 v102, 1.0, v102
    v_fmac_f32 v83, v166, v155
    s_waitcnt lgkmcnt(2)
    v_mfma_f32_16x16x32_bf16 v[64:67], a[48:51], a[208:211], v[64:67]
    v_rcp_f32 v102, v102
    v_mul_f32 v106, v174, v82
    v_mfma_f32_16x16x32_bf16 v[68:71], a[52:55], a[208:211], v[68:71]
    v_mul_f32 v93, v167, v81
    v_add_f32 v103, 1.0, v103
    v_mul_f32 v88, v88, v100
    v_mfma_f32_16x16x32_bf16 v[72:75], a[56:59], a[208:211], v[72:75]
    buffer_load_dwordx4 v7, s[20:23], s49 offen offset:3072 lds
    v_mfma_f32_16x16x32_bf16 v[64:67], a[60:63], a[212:215], v[64:67]
    ds_read_b128 a[192:195], v1 offset:40960
    v_exp_f32 v106, v106
    v_fmac_f32 v84, v166, v156
    v_mul_f32 v107, v174, v83
    ds_read_b128 a[196:199], v1 offset:41984
    v_rcp_f32 v103, v103
    v_mul_f32 v94, v167, v82
    v_add_f32 v104, 1.0, v104
    v_mfma_f32_16x16x32_bf16 v[68:71], a[64:67], a[212:215], v[68:71]
    v_exp_f32 v107, v107
    v_mul_f32 v89, v89, v101
    v_mfma_f32_16x16x32_bf16 v[72:75], a[68:71], a[212:215], v[72:75]
    v_rcp_f32 v104, v104
    s_add_u32 m0, s52, 131072
    s_add_u32 s49, s61, 131072
    v_fmac_f32 v85, v166, v157
    v_mul_f32 v108, v174, v84
    s_waitcnt lgkmcnt(2)
    v_mfma_f32_16x16x32_bf16 v[64:67], a[72:75], a[216:219], v[64:67]
    buffer_load_dwordx4 v4, s[20:23], s49 offen lds
    v_mfma_f32_16x16x32_bf16 v[68:71], a[76:79], a[216:219], v[68:71]
    v_exp_f32 v108, v108
    v_mul_f32 v95, v167, v83
    v_add_f32 v105, 1.0, v105
    v_mul_f32 v90, v90, v102
    v_fmac_f32 v86, v166, v158
    v_mul_f32 v109, v174, v85
    v_mfma_f32_16x16x32_bf16 v[72:75], a[80:83], a[216:219], v[72:75]
    ds_read_b128 a[200:203], v1 offset:43008
    v_rcp_f32 v105, v105
    v_mul_f32 v96, v167, v84
    v_mfma_f32_16x16x32_bf16 v[64:67], a[84:87], a[220:223], v[64:67]
    ds_read_b128 a[204:207], v1 offset:44032
    v_exp_f32 v109, v109
    v_add_f32 v106, 1.0, v106
    v_mul_f32 v91, v91, v103
    v_mfma_f32_16x16x32_bf16 v[68:71], a[88:91], a[220:223], v[68:71]
    buffer_load_dwordx4 v5, s[20:23], s49 offen offset:1024 lds
    v_mfma_f32_16x16x32_bf16 v[72:75], a[92:95], a[220:223], v[72:75]
    v_rcp_f32 v106, v106
    v_fmac_f32 v87, v166, v159
    v_mul_f32 v110, v174, v86
    v_mul_f32 v97, v167, v85
    v_add_f32 v107, 1.0, v107
    v_mul_f32 v92, v92, v104
    s_waitcnt lgkmcnt(2)
    v_mfma_f32_16x16x32_bf16 v[64:67], a[96:99], a[192:195], v[64:67]
    v_exp_f32 v110, v110
    v_mul_f32 v111, v174, v87
    v_mfma_f32_16x16x32_bf16 v[68:71], a[100:103], a[192:195], v[68:71]
    v_rcp_f32 v107, v107
    v_mul_f32 v98, v167, v86
    v_add_f32 v108, 1.0, v108
    v_mfma_f32_16x16x32_bf16 v[72:75], a[104:107], a[192:195], v[72:75]
    ds_read_b128 a[208:211], v1 offset:45056
    v_exp_f32 v111, v111
    v_rcp_f32 v108, v108
    v_mul_f32 v93, v93, v105
    v_mfma_f32_16x16x32_bf16 v[64:67], a[108:111], a[196:199], v[64:67]
    buffer_load_dwordx4 v6, s[20:23], s49 offen offset:2048 lds
    v_mfma_f32_16x16x32_bf16 v[68:71], a[112:115], a[196:199], v[68:71]
    ds_read_b128 a[212:215], v1 offset:46080
    v_mul_f32 v99, v167, v87
    v_add_f32 v109, 1.0, v109
    v_rcp_f32 v109, v109
    v_mul_f32 v94, v94, v106
    v_add_f32 v110, 1.0, v110
    v_mfma_f32_16x16x32_bf16 v[72:75], a[116:119], a[196:199], v[72:75]
    v_rcp_f32 v110, v110
    v_mul_f32 v95, v95, v107
    v_add_f32 v111, 1.0, v111
    s_waitcnt lgkmcnt(2)
    v_mfma_f32_16x16x32_bf16 v[64:67], a[120:123], a[200:203], v[64:67]
    v_rcp_f32 v111, v111
    v_mul_f32 v96, v96, v108
    v_mul_f32 v97, v97, v109
    v_mfma_f32_16x16x32_bf16 v[68:71], a[124:127], a[200:203], v[68:71]
    buffer_load_dwordx4 v7, s[20:23], s49 offen offset:3072 lds
    v_mfma_f32_16x16x32_bf16 v[72:75], a[128:131], a[200:203], v[72:75]
    v_mul_f32 v98, v98, v110
    v_mul_f32 v99, v99, v111
    v_cvt_pk_bf16_f32 v114, v88, v89
    ds_read_b128 a[216:219], v1 offset:47104
    v_cvt_pk_bf16_f32 v115, v90, v91
    v_cvt_pk_bf16_f32 v118, v92, v93
    v_mfma_f32_16x16x32_bf16 v[64:67], a[132:135], a[204:207], v[64:67]
    ds_read_b128 a[220:223], v1 offset:48128
    v_cvt_pk_bf16_f32 v119, v94, v95
    v_cvt_pk_bf16_f32 v122, v96, v97
    v_cvt_pk_bf16_f32 v123, v98, v99
    v_mfma_f32_16x16x32_bf16 v[68:71], a[136:139], a[204:207], v[68:71]
    s_mov_b32 s42, 294912
    v_permlane16_swap_b32 v112, v114
    v_permlane16_swap_b32 v113, v115
    v_permlane16_swap_b32 v116, v118
    v_mfma_f32_16x16x32_bf16 v[72:75], a[140:143], a[204:207], v[72:75]
    buffer_load_dword v238, v124, s[20:23], s42 offen sc1
    s_waitcnt lgkmcnt(2)
    v_mfma_f32_16x16x32_bf16 v[64:67], a[144:147], a[208:211], v[64:67]
    v_permlane16_swap_b32 v117, v119
    v_permlane16_swap_b32 v120, v122
    v_permlane16_swap_b32 v121, v123
    v_mfma_f32_16x16x32_bf16 v[68:71], a[148:151], a[208:211], v[68:71]
    buffer_store_dwordx4 v[112:115], v61, s[32:35], s58 offen offset:0 sc1
    v_mfma_f32_16x16x32_bf16 v[72:75], a[152:155], a[208:211], v[72:75]
    s_waitcnt vmcnt(19)
    s_barrier
    ds_read_b128 a[192:195], v1 offset:49152
    ds_read_b128 a[196:199], v1 offset:50176
    v_mfma_f32_16x16x32_bf16 v[64:67], a[156:159], a[212:215], v[64:67]
    v_mfma_f32_16x16x32_bf16 v[68:71], a[160:163], a[212:215], v[68:71]
    v_mfma_f32_16x16x32_bf16 v[72:75], a[164:167], a[212:215], v[72:75]
    s_waitcnt lgkmcnt(2)
    v_mfma_f32_16x16x32_bf16 v[64:67], a[168:171], a[216:219], v[64:67]
    buffer_store_dwordx4 v[116:119], v61, s[32:35], s59 offen offset:0 sc1
    v_mfma_f32_16x16x32_bf16 v[68:71], a[172:175], a[216:219], v[68:71]
    ds_read_b128 a[200:203], v1 offset:51200
    ds_read_b128 a[204:207], v1 offset:52224
    v_mfma_f32_16x16x32_bf16 v[72:75], a[176:179], a[216:219], v[72:75]
    v_mfma_f32_16x16x32_bf16 v[64:67], a[180:183], a[220:223], v[64:67]
    v_mfma_f32_16x16x32_bf16 v[68:71], a[184:187], a[220:223], v[68:71]
    v_mfma_f32_16x16x32_bf16 v[72:75], a[188:191], a[220:223], v[72:75]
    buffer_store_dwordx4 v[120:123], v61, s[32:35], s60 offen offset:0 sc1
    s_waitcnt lgkmcnt(2)
    v_mfma_f32_16x16x32_bf16 v[76:79], a[0:3], a[192:195], 0
    s_add_u32 m0, s52, 147456
    s_add_u32 s49, s61, 163840
    v_mfma_f32_16x16x32_bf16 v[80:83], a[4:7], a[192:195], 0
    buffer_load_dwordx4 v4, s[20:23], s49 offen lds
    v_mfma_f32_16x16x32_bf16 v[84:87], a[8:11], a[192:195], 0
    v_fmac_f32 v64, v168, v148
    ds_read_b128 a[208:211], v1 offset:53248
    v_fmac_f32 v65, v168, v149
    v_mul_f32 v100, v176, v64
    v_mfma_f32_16x16x32_bf16 v[76:79], a[12:15], a[196:199], v[76:79]
    ds_read_b128 a[212:215], v1 offset:54272
    v_exp_f32 v100, v100
    v_fmac_f32 v66, v168, v150
    v_mfma_f32_16x16x32_bf16 v[80:83], a[16:19], a[196:199], v[80:83]
    buffer_load_dwordx4 v5, s[20:23], s49 offen offset:1024 lds
    v_mfma_f32_16x16x32_bf16 v[84:87], a[20:23], a[196:199], v[84:87]
    v_mul_f32 v101, v176, v65
    v_exp_f32 v101, v101
    v_mul_f32 v88, v169, v64
    v_fmac_f32 v67, v168, v151
    s_waitcnt lgkmcnt(2)
    v_mfma_f32_16x16x32_bf16 v[76:79], a[24:27], a[200:203], v[76:79]
    v_mul_f32 v102, v176, v66
    v_mul_f32 v89, v169, v65
    v_mfma_f32_16x16x32_bf16 v[80:83], a[28:31], a[200:203], v[80:83]
    v_exp_f32 v102, v102
    v_fmac_f32 v68, v168, v152
    ds_read_b128 a[216:219], v1 offset:55296
    v_mfma_f32_16x16x32_bf16 v[84:87], a[32:35], a[200:203], v[84:87]
    buffer_load_dwordx4 v6, s[20:23], s49 offen offset:2048 lds
    v_mfma_f32_16x16x32_bf16 v[76:79], a[36:39], a[204:207], v[76:79]
    v_mul_f32 v103, v176, v67
    v_mul_f32 v90, v169, v66
    ds_read_b128 a[220:223], v1 offset:56320
    v_exp_f32 v103, v103
    v_add_f32 v100, 1.0, v100
    v_mfma_f32_16x16x32_bf16 v[80:83], a[40:43], a[204:207], v[80:83]
    v_fmac_f32 v69, v168, v153
    v_mul_f32 v104, v176, v68
    v_mfma_f32_16x16x32_bf16 v[84:87], a[44:47], a[204:207], v[84:87]
    v_rcp_f32 v100, v100
    v_mul_f32 v91, v169, v67
    s_waitcnt lgkmcnt(2)
    v_mfma_f32_16x16x32_bf16 v[76:79], a[48:51], a[208:211], v[76:79]
    buffer_load_dwordx4 v7, s[20:23], s49 offen offset:3072 lds
    v_mfma_f32_16x16x32_bf16 v[80:83], a[52:55], a[208:211], v[80:83]
    v_exp_f32 v104, v104
    v_add_f32 v101, 1.0, v101
    v_fmac_f32 v70, v168, v154
    v_mul_f32 v105, v176, v69
    v_mfma_f32_16x16x32_bf16 v[84:87], a[56:59], a[208:211], v[84:87]
    ds_read_b128 a[192:195], v1 offset:57344
    v_rcp_f32 v101, v101
    v_mul_f32 v92, v169, v68
    v_mfma_f32_16x16x32_bf16 v[76:79], a[60:63], a[212:215], v[76:79]
    ds_read_b128 a[196:199], v1 offset:58368
    v_exp_f32 v105, v105
    s_mov_b32 m0, s52
    s_add_u32 s49, s68, 196608
    v_add_f32 v102, 1.0, v102
    v_mfma_f32_16x16x32_bf16 v[80:83], a[64:67], a[212:215], v[80:83]
    buffer_load_dwordx4 v4, s[20:23], s49 offen lds
    v_mfma_f32_16x16x32_bf16 v[84:87], a[68:71], a[212:215], v[84:87]
    v_rcp_f32 v102, v102
    v_fmac_f32 v71, v168, v155
    v_mul_f32 v106, v176, v70
    v_mul_f32 v93, v169, v69
    s_waitcnt lgkmcnt(2)
    v_mfma_f32_16x16x32_bf16 v[76:79], a[72:75], a[216:219], v[76:79]
    v_add_f32 v103, 1.0, v103
    v_mul_f32 v88, v88, v100
    v_mfma_f32_16x16x32_bf16 v[80:83], a[76:79], a[216:219], v[80:83]
    v_exp_f32 v106, v106
    v_fmac_f32 v72, v168, v156
    ds_read_b128 a[200:203], v1 offset:59392
    v_mfma_f32_16x16x32_bf16 v[84:87], a[80:83], a[216:219], v[84:87]
    buffer_load_dwordx4 v5, s[20:23], s49 offen offset:1024 lds
    v_mfma_f32_16x16x32_bf16 v[76:79], a[84:87], a[220:223], v[76:79]
    v_rcp_f32 v103, v103
    v_mul_f32 v107, v176, v71
    ds_read_b128 a[204:207], v1 offset:60416
    v_mul_f32 v94, v169, v70
    v_add_f32 v104, 1.0, v104
    v_mfma_f32_16x16x32_bf16 v[80:83], a[88:91], a[220:223], v[80:83]
    v_exp_f32 v107, v107
    v_mul_f32 v89, v89, v101
    v_mfma_f32_16x16x32_bf16 v[84:87], a[92:95], a[220:223], v[84:87]
    v_fmac_f32 v73, v168, v157
    v_mul_f32 v108, v176, v72
    s_waitcnt lgkmcnt(2)
    v_mfma_f32_16x16x32_bf16 v[76:79], a[96:99], a[192:195], v[76:79]
    buffer_load_dwordx4 v6, s[20:23], s49 offen offset:2048 lds
    v_mfma_f32_16x16x32_bf16 v[80:83], a[100:103], a[192:195], v[80:83]
    v_rcp_f32 v104, v104
    v_mul_f32 v95, v169, v71
    v_add_f32 v105, 1.0, v105
    v_mfma_f32_16x16x32_bf16 v[84:87], a[104:107], a[192:195], v[84:87]
    ds_read_b128 a[208:211], v1 offset:61440
    v_exp_f32 v108, v108
    v_mul_f32 v90, v90, v102
    v_mfma_f32_16x16x32_bf16 v[76:79], a[108:111], a[196:199], v[76:79]
    buffer_load_dwordx4 v7, s[20:23], s49 offen offset:3072 lds
    v_mfma_f32_16x16x32_bf16 v[80:83], a[112:115], a[196:199], v[80:83]
    ds_read_b128 a[212:215], v1 offset:62464
    v_rcp_f32 v105, v105
    v_fmac_f32 v74, v168, v158
    v_mul_f32 v109, v176, v73
    v_mul_f32 v96, v169, v72
    v_mfma_f32_16x16x32_bf16 v[84:87], a[116:119], a[196:199], v[84:87]
    v_add_f32 v106, 1.0, v106
    v_mul_f32 v91, v91, v103
    s_waitcnt lgkmcnt(2)
    v_mfma_f32_16x16x32_bf16 v[76:79], a[120:123], a[200:203], v[76:79]
    v_exp_f32 v109, v109
    s_add_u32 m0, s52, 16384
    s_add_u32 s49, s68, 229376
    v_fmac_f32 v75, v168, v159
    v_mfma_f32_16x16x32_bf16 v[80:83], a[124:127], a[200:203], v[80:83]
    buffer_load_dwordx4 v4, s[20:23], s49 offen lds
    v_mfma_f32_16x16x32_bf16 v[84:87], a[128:131], a[200:203], v[84:87]
    v_rcp_f32 v106, v106
    v_mul_f32 v110, v176, v74
    ds_read_b128 a[216:219], v1 offset:63488
    v_mul_f32 v97, v169, v73
    v_add_f32 v107, 1.0, v107
    v_mfma_f32_16x16x32_bf16 v[76:79], a[132:135], a[204:207], v[76:79]
    ds_read_b128 a[220:223], v1 offset:64512
    v_exp_f32 v110, v110
    v_mul_f32 v92, v92, v104
    v_mfma_f32_16x16x32_bf16 v[80:83], a[136:139], a[204:207], v[80:83]
    v_rcp_f32 v107, v107
    v_mul_f32 v111, v176, v75
    v_mfma_f32_16x16x32_bf16 v[84:87], a[140:143], a[204:207], v[84:87]
    buffer_load_dwordx4 v5, s[20:23], s49 offen offset:1024 lds
    s_waitcnt lgkmcnt(2)
    v_mfma_f32_16x16x32_bf16 v[76:79], a[144:147], a[208:211], v[76:79]
    v_exp_f32 v111, v111
    v_mul_f32 v98, v169, v74
    v_add_f32 v108, 1.0, v108
    v_mul_f32 v93, v93, v105
    v_mfma_f32_16x16x32_bf16 v[80:83], a[148:151], a[208:211], v[80:83]
    v_rcp_f32 v108, v108
    v_mul_f32 v99, v169, v75
    v_mfma_f32_16x16x32_bf16 v[84:87], a[152:155], a[208:211], v[84:87]
    v_add_f32 v109, 1.0, v109
    v_mul_f32 v94, v94, v106
    v_mfma_f32_16x16x32_bf16 v[76:79], a[156:159], a[212:215], v[76:79]
    buffer_load_dwordx4 v6, s[20:23], s49 offen offset:2048 lds
    v_mfma_f32_16x16x32_bf16 v[80:83], a[160:163], a[212:215], v[80:83]
    v_rcp_f32 v109, v109
    v_add_f32 v110, 1.0, v110
    v_rcp_f32 v110, v110
    v_mul_f32 v95, v95, v107
    v_mfma_f32_16x16x32_bf16 v[84:87], a[164:167], a[212:215], v[84:87]
    v_add_f32 v111, 1.0, v111
    v_mul_f32 v96, v96, v108
    s_waitcnt lgkmcnt(0)
    v_mfma_f32_16x16x32_bf16 v[76:79], a[168:171], a[216:219], v[76:79]
    v_rcp_f32 v111, v111
    v_mul_f32 v97, v97, v109
    v_mul_f32 v98, v98, v110
    v_mul_f32 v99, v99, v111
    v_mfma_f32_16x16x32_bf16 v[80:83], a[172:175], a[216:219], v[80:83]
    buffer_load_dwordx4 v7, s[20:23], s49 offen offset:3072 lds
    v_mfma_f32_16x16x32_bf16 v[84:87], a[176:179], a[216:219], v[84:87]
    v_cvt_pk_bf16_f32 v112, v88, v89
    v_cvt_pk_bf16_f32 v113, v90, v91
    v_mfma_f32_16x16x32_bf16 v[76:79], a[180:183], a[220:223], v[76:79]
    v_cvt_pk_bf16_f32 v116, v92, v93
    v_cvt_pk_bf16_f32 v117, v94, v95
    v_cvt_pk_bf16_f32 v120, v96, v97
    v_mfma_f32_16x16x32_bf16 v[80:83], a[184:187], a[220:223], v[80:83]
    v_cvt_pk_bf16_f32 v121, v98, v99
    v_mfma_f32_16x16x32_bf16 v[84:87], a[188:191], a[220:223], v[84:87]
    s_barrier
    s_nop 0
    v_pk_fma_f32 v[88:89], v[148:149], v[170:171], v[76:77] op_sel_hi:[1,0,1]
    v_pk_fma_f32 v[90:91], v[150:151], v[170:171], v[78:79] op_sel_hi:[1,0,1]
    s_nop 1
    v_pk_fma_f32 v[92:93], v[152:153], v[170:171], v[80:81] op_sel_hi:[1,0,1]
    v_pk_fma_f32 v[94:95], v[154:155], v[170:171], v[82:83] op_sel_hi:[1,0,1]
    v_pk_fma_f32 v[96:97], v[156:157], v[170:171], v[84:85] op_sel_hi:[1,0,1]
    v_pk_fma_f32 v[98:99], v[158:159], v[170:171], v[86:87] op_sel_hi:[1,0,1]
    v_pk_mul_f32 v[100:101], v[88:89], v[178:179] op_sel_hi:[1,0]
    v_pk_mul_f32 v[102:103], v[90:91], v[178:179] op_sel_hi:[1,0]
    v_pk_mul_f32 v[104:105], v[92:93], v[178:179] op_sel_hi:[1,0]
    v_pk_mul_f32 v[106:107], v[94:95], v[178:179] op_sel_hi:[1,0]
    v_pk_mul_f32 v[108:109], v[96:97], v[178:179] op_sel_hi:[1,0]
    v_pk_mul_f32 v[110:111], v[98:99], v[178:179] op_sel_hi:[1,0]
    v_exp_f32 v100, v100
    v_exp_f32 v101, v101
    v_exp_f32 v102, v102
    v_exp_f32 v103, v103
    v_pk_mul_f32 v[88:89], v[88:89], v[170:171] op_sel:[0,1] op_sel_hi:[1,1]
    v_pk_mul_f32 v[90:91], v[90:91], v[170:171] op_sel:[0,1] op_sel_hi:[1,1]
    v_exp_f32 v104, v104
    v_exp_f32 v105, v105
    v_exp_f32 v106, v106
    v_exp_f32 v107, v107
    v_pk_mul_f32 v[92:93], v[92:93], v[170:171] op_sel:[0,1] op_sel_hi:[1,1]
    v_pk_mul_f32 v[94:95], v[94:95], v[170:171] op_sel:[0,1] op_sel_hi:[1,1]
    v_exp_f32 v108, v108
    v_exp_f32 v109, v109
    v_exp_f32 v110, v110
    v_exp_f32 v111, v111
    v_pk_mul_f32 v[96:97], v[96:97], v[170:171] op_sel:[0,1] op_sel_hi:[1,1]
    v_pk_mul_f32 v[98:99], v[98:99], v[170:171] op_sel:[0,1] op_sel_hi:[1,1]
    v_pk_add_f32 v[100:101], v[100:101], 1.0 op_sel_hi:[1,0]
    v_pk_add_f32 v[102:103], v[102:103], 1.0 op_sel_hi:[1,0]
    v_pk_add_f32 v[104:105], v[104:105], 1.0 op_sel_hi:[1,0]
    v_pk_add_f32 v[106:107], v[106:107], 1.0 op_sel_hi:[1,0]
    v_pk_add_f32 v[108:109], v[108:109], 1.0 op_sel_hi:[1,0]
    v_pk_add_f32 v[110:111], v[110:111], 1.0 op_sel_hi:[1,0]
    v_rcp_f32 v100, v100
    v_rcp_f32 v101, v101
    v_rcp_f32 v102, v102
    v_rcp_f32 v103, v103
    v_rcp_f32 v104, v104
    v_rcp_f32 v105, v105
    v_rcp_f32 v106, v106
    v_rcp_f32 v107, v107
    v_rcp_f32 v108, v108
    v_rcp_f32 v109, v109
    v_rcp_f32 v110, v110
    v_rcp_f32 v111, v111
    v_pk_mul_f32 v[88:89], v[88:89], v[100:101]
    v_pk_mul_f32 v[90:91], v[90:91], v[102:103]
    v_pk_mul_f32 v[92:93], v[92:93], v[104:105]
    v_pk_mul_f32 v[94:95], v[94:95], v[106:107]
    v_pk_mul_f32 v[96:97], v[96:97], v[108:109]
    v_pk_mul_f32 v[98:99], v[98:99], v[110:111]
    v_cvt_pk_bf16_f32 v114, v88, v89
    v_cvt_pk_bf16_f32 v115, v90, v91
    v_cvt_pk_bf16_f32 v118, v92, v93
    v_cvt_pk_bf16_f32 v119, v94, v95
    v_cvt_pk_bf16_f32 v122, v96, v97
    v_cvt_pk_bf16_f32 v123, v98, v99
    v_permlane16_swap_b32 v112, v114
    v_permlane16_swap_b32 v113, v115
    v_permlane16_swap_b32 v116, v118
    v_permlane16_swap_b32 v117, v119
    v_permlane16_swap_b32 v120, v122
    v_permlane16_swap_b32 v121, v123
    buffer_store_dwordx4 v[112:115], v61, s[32:35], s58 offen offset:2048 sc1
    buffer_store_dwordx4 v[116:119], v61, s[32:35], s59 offen offset:2048 sc1
    buffer_store_dwordx4 v[120:123], v61, s[32:35], s60 offen offset:2048 sc1
    s_waitcnt vmcnt(0)
    v_mov_b32 v62, 3
    s_cmp_eq_u32 s47, 1
    s_cbranch_scc0 L_pub_slow3
    buffer_store_dword v62, v29, s[28:31], 0 offen
L_pub_done3:
    s_add_u32 m0, s52, 32768
    s_add_u32 s49, s68, 262144
    buffer_load_dwordx4 v4, s[20:23], s49 offen lds
    buffer_load_dwordx4 v5, s[20:23], s49 offen offset:1024 lds
    buffer_load_dwordx4 v6, s[20:23], s49 offen offset:2048 lds
    buffer_load_dwordx4 v7, s[20:23], s49 offen offset:3072 lds
    s_add_u32 m0, s52, 49152
    s_add_u32 s49, s68, 294912
    buffer_load_dwordx4 v4, s[20:23], s49 offen lds
    buffer_load_dwordx4 v5, s[20:23], s49 offen offset:1024 lds
    buffer_load_dwordx4 v6, s[20:23], s49 offen offset:2048 lds
    buffer_load_dwordx4 v7, s[20:23], s49 offen offset:3072 lds
    v_lshlrev_b32 v64, 16, v140
    v_and_b32 v65, 0xffff0000, v140
    v_lshlrev_b32 v66, 16, v141
    v_and_b32 v67, 0xffff0000, v141
    v_lshlrev_b32 v68, 16, v142
    v_and_b32 v69, 0xffff0000, v142
    v_lshlrev_b32 v70, 16, v143
    v_and_b32 v71, 0xffff0000, v143
    v_lshlrev_b32 v72, 16, v144
    v_and_b32 v73, 0xffff0000, v144
    v_lshlrev_b32 v74, 16, v145
    v_and_b32 v75, 0xffff0000, v145
    v_lshlrev_b32 v76, 16, v146
    v_and_b32 v77, 0xffff0000, v146
    v_lshlrev_b32 v78, 16, v147
    v_and_b32 v79, 0xffff0000, v147
    v_add_u32 v19, s52, v19
    v_add_u32 v19, 65536, v19
    v_add_u32 v20, s52, v20
    v_add_u32 v20, 65536, v20
    v_add_u32 v21, s52, v21
    v_add_u32 v21, 65536, v21
    v_add_u32 v22, s52, v22
    v_add_u32 v22, 65536, v22
    ds_read_b64_tr_b16 v[164:165], v19 offset:0
    ds_read_b64_tr_b16 v[166:167], v19 offset:512
    ds_read_b64_tr_b16 v[168:169], v20 offset:0
    ds_read_b64_tr_b16 v[170:171], v20 offset:512
    ds_read_b64_tr_b16 v[172:173], v21 offset:0
    ds_read_b64_tr_b16 v[174:175], v21 offset:512
    ds_read_b64_tr_b16 v[176:177], v22 offset:0
    ds_read_b64_tr_b16 v[178:179], v22 offset:512
    s_mov_b32 s53, 0
    buffer_load_dword v63, v30, s[28:31], 0 offen sc1
L_poll3:
    buffer_load_dword v60, v30, s[28:31], 0 offen sc1
    s_waitcnt vmcnt(1)
    v_cmp_le_u32 vcc, 3, v63
    s_nop 0
    s_cmp_eq_u64 vcc, -1
    s_cbranch_scc1 L_poll_ok3
    buffer_load_dword v63, v30, s[28:31], 0 offen sc1
    s_waitcnt vmcnt(1)
    v_cmp_le_u32 vcc, 3, v60
    s_nop 0
    s_cmp_eq_u64 vcc, -1
    s_cbranch_scc1 L_poll_ok3
    s_add_u32 s53, s53, 1
    s_cmp_lt_u32 s53, 0x20000
    s_cbranch_scc1 L_poll3
    s_branch L_end
L_poll_ok3:
    s_cmp_eq_u32 s47, 1
    s_cbranch_scc0 L_acq_slow3
L_acq_done3:
    s_add_u32 s48, s69, 0
    buffer_load_dwordx4 a[0:3], v32, s[32:35], s48 offen sc1
    buffer_load_dwordx4 a[4:7], v33, s[32:35], s48 offen sc1
    buffer_load_dwordx4 a[8:11], v34, s[32:35], s48 offen sc1
    buffer_load_dwordx4 a[12:15], v35, s[32:35], s48 offen sc1
    s_add_u32 s48, s69, 4096
    buffer_load_dwordx4 a[16:19], v32, s[32:35], s48 offen sc1
    buffer_load_dwordx4 a[20:23], v33, s[32:35], s48 offen sc1
    buffer_load_dwordx4 a[24:27], v34, s[32:35], s48 offen sc1
    buffer_load_dwordx4 a[28:31], v35, s[32:35], s48 offen sc1
    s_add_u32 s48, s69, 8192
    buffer_load_dwordx4 a[32:35], v32, s[32:35], s48 offen sc1
    buffer_load_dwordx4 a[36:39], v33, s[32:35], s48 offen sc1
    buffer_load_dwordx4 a[40:43], v34, s[32:35], s48 offen sc1
    buffer_load_dwordx4 a[44:47], v35, s[32:35], s48 offen sc1
    s_waitcnt vmcnt(8) lgkmcnt(0)
    v_mfma_f32_16x16x32_bf16 v[64:67], v[164:167], a[0:3], v[64:67]
    s_add_u32 s48, s69, 12288
    v_mfma_f32_16x16x32_bf16 v[80:83], v[164:167], a[4:7], 0
    buffer_load_dwordx4 a[48:51], v32, s[32:35], s48 offen sc1
    v_mfma_f32_16x16x32_bf16 v[96:99], v[164:167], a[8:11], 0
    buffer_load_dwordx4 a[52:55], v33, s[32:35], s48 offen sc1
    ds_read_b64_tr_b16 v[180:181], v19 offset:16384
    v_mfma_f32_16x16x32_bf16 v[112:115], v[164:167], a[12:15], 0
    ds_read_b64_tr_b16 v[182:183], v19 offset:16896
    v_mfma_f32_16x16x32_bf16 v[68:71], v[168:171], a[0:3], v[68:71]
    buffer_load_dwordx4 a[56:59], v34, s[32:35], s48 offen sc1
    v_mfma_f32_16x16x32_bf16 v[84:87], v[168:171], a[4:7], 0
    ds_read_b64_tr_b16 v[184:185], v20 offset:16384
    ds_read_b64_tr_b16 v[186:187], v20 offset:16896
    v_mfma_f32_16x16x32_bf16 v[100:103], v[168:171], a[8:11], 0
    buffer_load_dwordx4 a[60:63], v35, s[32:35], s48 offen sc1
    v_mfma_f32_16x16x32_bf16 v[116:119], v[168:171], a[12:15], 0
    ds_read_b64_tr_b16 v[188:189], v21 offset:16384
    s_add_u32 m0, s52, 65536
    s_add_u32 s49, s68, 327680
    v_mfma_f32_16x16x32_bf16 v[72:75], v[172:175], a[0:3], v[72:75]
    buffer_load_dwordx4 v4, s[20:23], s49 offen lds
    v_mfma_f32_16x16x32_bf16 v[88:91], v[172:175], a[4:7], 0
    ds_read_b64_tr_b16 v[190:191], v21 offset:16896
    v_mfma_f32_16x16x32_bf16 v[104:107], v[172:175], a[8:11], 0
    buffer_load_dwordx4 v5, s[20:23], s49 offen offset:1024 lds
    v_mfma_f32_16x16x32_bf16 v[120:123], v[172:175], a[12:15], 0
    ds_read_b64_tr_b16 v[192:193], v22 offset:16384
    v_mfma_f32_16x16x32_bf16 v[76:79], v[176:179], a[0:3], v[76:79]
    buffer_load_dwordx4 v6, s[20:23], s49 offen offset:2048 lds
    v_mfma_f32_16x16x32_bf16 v[92:95], v[176:179], a[4:7], 0
    ds_read_b64_tr_b16 v[194:195], v22 offset:16896
    v_mfma_f32_16x16x32_bf16 v[108:111], v[176:179], a[8:11], 0
    buffer_load_dwordx4 v7, s[20:23], s49 offen offset:3072 lds
    v_mfma_f32_16x16x32_bf16 v[124:127], v[176:179], a[12:15], 0
    s_waitcnt vmcnt(12) lgkmcnt(0)
    v_mfma_f32_16x16x32_bf16 v[64:67], v[180:183], a[16:19], v[64:67]
    s_add_u32 s48, s69, 16384
    v_mfma_f32_16x16x32_bf16 v[80:83], v[180:183], a[20:23], v[80:83]
    buffer_load_dwordx4 a[64:67], v32, s[32:35], s48 offen sc1
    v_mfma_f32_16x16x32_bf16 v[96:99], v[180:183], a[24:27], v[96:99]
    ds_read_b64_tr_b16 v[164:165], v19 offset:32768
    v_mfma_f32_16x16x32_bf16 v[112:115], v[180:183], a[28:31], v[112:115]
    ds_read_b64_tr_b16 v[166:167], v19 offset:33280
    ds_read_b64_tr_b16 v[168:169], v20 offset:32768
    v_mfma_f32_16x16x32_bf16 v[68:71], v[184:187], a[16:19], v[68:71]
    buffer_load_dwordx4 a[68:71], v33, s[32:35], s48 offen sc1
    v_mfma_f32_16x16x32_bf16 v[84:87], v[184:187], a[20:23], v[84:87]
    ds_read_b64_tr_b16 v[170:171], v20 offset:33280
    v_mfma_f32_16x16x32_bf16 v[100:103], v[184:187], a[24:27], v[100:103]
    ds_read_b64_tr_b16 v[172:173], v21 offset:32768
    v_mfma_f32_16x16x32_bf16 v[116:119], v[184:187], a[28:31], v[116:119]
    ds_read_b64_tr_b16 v[174:175], v21 offset:33280
    ds_read_b64_tr_b16 v[176:177], v22 offset:32768
    v_mfma_f32_16x16x32_bf16 v[72:75], v[188:191], a[16:19], v[72:75]
    buffer_load_dwordx4 a[72:75], v34, s[32:35], s48 offen sc1
    v_mfma_f32_16x16x32_bf16 v[88:91], v[188:191], a[20:23], v[88:91]
    ds_read_b64_tr_b16 v[178:179], v22 offset:33280
    v_mfma_f32_16x16x32_bf16 v[104:107], v[188:191], a[24:27], v[104:107]
    v_mfma_f32_16x16x32_bf16 v[120:123], v[188:191], a[28:31], v[120:123]
    v_mfma_f32_16x16x32_bf16 v[76:79], v[192:195], a[16:19], v[76:79]
    buffer_load_dwordx4 a[76:79], v35, s[32:35], s48 offen sc1
    v_mfma_f32_16x16x32_bf16 v[92:95], v[192:195], a[20:23], v[92:95]
    v_mfma_f32_16x16x32_bf16 v[108:111], v[192:195], a[24:27], v[108:111]
    v_mfma_f32_16x16x32_bf16 v[124:127], v[192:195], a[28:31], v[124:127]
    s_waitcnt vmcnt(12) lgkmcnt(0)
    v_mfma_f32_16x16x32_bf16 v[64:67], v[164:167], a[32:35], v[64:67]
    s_add_u32 s48, s69, 20480
    v_mfma_f32_16x16x32_bf16 v[80:83], v[164:167], a[36:39], v[80:83]
    buffer_load_dwordx4 a[80:83], v32, s[32:35], s48 offen sc1
    v_mfma_f32_16x16x32_bf16 v[96:99], v[164:167], a[40:43], v[96:99]
    ds_read_b64_tr_b16 v[180:181], v19 offset:49152
    v_mfma_f32_16x16x32_bf16 v[112:115], v[164:167], a[44:47], v[112:115]
    ds_read_b64_tr_b16 v[182:183], v19 offset:49664
    ds_read_b64_tr_b16 v[184:185], v20 offset:49152
    v_mfma_f32_16x16x32_bf16 v[68:71], v[168:171], a[32:35], v[68:71]
    buffer_load_dwordx4 a[84:87], v33, s[32:35], s48 offen sc1
    v_mfma_f32_16x16x32_bf16 v[84:87], v[168:171], a[36:39], v[84:87]
    ds_read_b64_tr_b16 v[186:187], v20 offset:49664
    v_mfma_f32_16x16x32_bf16 v[100:103], v[168:171], a[40:43], v[100:103]
    ds_read_b64_tr_b16 v[188:189], v21 offset:49152
    v_mfma_f32_16x16x32_bf16 v[116:119], v[168:171], a[44:47], v[116:119]
    ds_read_b64_tr_b16 v[190:191], v21 offset:49664
    ds_read_b64_tr_b16 v[192:193], v22 offset:49152
    v_mfma_f32_16x16x32_bf16 v[72:75], v[172:175], a[32:35], v[72:75]
    buffer_load_dwordx4 a[88:91], v34, s[32:35], s48 offen sc1
    v_mfma_f32_16x16x32_bf16 v[88:91], v[172:175], a[36:39], v[88:91]
    ds_read_b64_tr_b16 v[194:195], v22 offset:49664
    v_mfma_f32_16x16x32_bf16 v[104:107], v[172:175], a[40:43], v[104:107]
    v_mfma_f32_16x16x32_bf16 v[120:123], v[172:175], a[44:47], v[120:123]
    v_mfma_f32_16x16x32_bf16 v[76:79], v[176:179], a[32:35], v[76:79]
    buffer_load_dwordx4 a[92:95], v35, s[32:35], s48 offen sc1
    v_mfma_f32_16x16x32_bf16 v[92:95], v[176:179], a[36:39], v[92:95]
    v_mfma_f32_16x16x32_bf16 v[108:111], v[176:179], a[40:43], v[108:111]
    v_mfma_f32_16x16x32_bf16 v[124:127], v[176:179], a[44:47], v[124:127]
    s_waitcnt vmcnt(12) lgkmcnt(0)
    v_mfma_f32_16x16x32_bf16 v[64:67], v[180:183], a[48:51], v[64:67]
    s_add_u32 s48, s70, 24576
    v_mfma_f32_16x16x32_bf16 v[80:83], v[180:183], a[52:55], v[80:83]
    buffer_load_dwordx4 a[96:99], v32, s[32:35], s48 offen sc1
    v_mfma_f32_16x16x32_bf16 v[96:99], v[180:183], a[56:59], v[96:99]
    v_add_u32 v19, 65536, v19
    v_add_u32 v20, 65536, v20
    v_mfma_f32_16x16x32_bf16 v[112:115], v[180:183], a[60:63], v[112:115]
    v_add_u32 v21, 65536, v21
    v_mfma_f32_16x16x32_bf16 v[68:71], v[184:187], a[48:51], v[68:71]
    buffer_load_dwordx4 a[100:103], v33, s[32:35], s48 offen sc1
    v_mfma_f32_16x16x32_bf16 v[84:87], v[184:187], a[52:55], v[84:87]
    v_add_u32 v22, 65536, v22
    ds_read_b64_tr_b16 v[164:165], v19 offset:0
    v_mfma_f32_16x16x32_bf16 v[100:103], v[184:187], a[56:59], v[100:103]
    ds_read_b64_tr_b16 v[166:167], v19 offset:512
    v_mfma_f32_16x16x32_bf16 v[116:119], v[184:187], a[60:63], v[116:119]
    ds_read_b64_tr_b16 v[168:169], v20 offset:0
    v_mfma_f32_16x16x32_bf16 v[72:75], v[188:191], a[48:51], v[72:75]
    buffer_load_dwordx4 a[104:107], v34, s[32:35], s48 offen sc1
    v_mfma_f32_16x16x32_bf16 v[88:91], v[188:191], a[52:55], v[88:91]
    ds_read_b64_tr_b16 v[170:171], v20 offset:512
    ds_read_b64_tr_b16 v[172:173], v21 offset:0
    v_mfma_f32_16x16x32_bf16 v[104:107], v[188:191], a[56:59], v[104:107]
    ds_read_b64_tr_b16 v[174:175], v21 offset:512
    v_mfma_f32_16x16x32_bf16 v[120:123], v[188:191], a[60:63], v[120:123]
    ds_read_b64_tr_b16 v[176:177], v22 offset:0
    v_mfma_f32_16x16x32_bf16 v[76:79], v[192:195], a[48:51], v[76:79]
    buffer_load_dwordx4 a[108:111], v35, s[32:35], s48 offen sc1
    v_mfma_f32_16x16x32_bf16 v[92:95], v[192:195], a[52:55], v[92:95]
    ds_read_b64_tr_b16 v[178:179], v22 offset:512
    v_mfma_f32_16x16x32_bf16 v[108:111], v[192:195], a[56:59], v[108:111]
    v_mfma_f32_16x16x32_bf16 v[124:127], v[192:195], a[60:63], v[124:127]
    s_waitcnt vmcnt(8) lgkmcnt(0)
    v_mfma_f32_16x16x32_bf16 v[64:67], v[164:167], a[64:67], v[64:67]
    s_add_u32 s48, s70, 28672
    v_mfma_f32_16x16x32_bf16 v[80:83], v[164:167], a[68:71], v[80:83]
    buffer_load_dwordx4 a[112:115], v32, s[32:35], s48 offen sc1
    v_mfma_f32_16x16x32_bf16 v[96:99], v[164:167], a[72:75], v[96:99]
    ds_read_b64_tr_b16 v[180:181], v19 offset:16384
    v_mfma_f32_16x16x32_bf16 v[112:115], v[164:167], a[76:79], v[112:115]
    ds_read_b64_tr_b16 v[182:183], v19 offset:16896
    ds_read_b64_tr_b16 v[184:185], v20 offset:16384
    v_mfma_f32_16x16x32_bf16 v[68:71], v[168:171], a[64:67], v[68:71]
    buffer_load_dwordx4 a[116:119], v33, s[32:35], s48 offen sc1
    v_mfma_f32_16x16x32_bf16 v[84:87], v[168:171], a[68:71], v[84:87]
    ds_read_b64_tr_b16 v[186:187], v20 offset:16896
    v_mfma_f32_16x16x32_bf16 v[100:103], v[168:171], a[72:75], v[100:103]
    ds_read_b64_tr_b16 v[188:189], v21 offset:16384
    v_mfma_f32_16x16x32_bf16 v[116:119], v[168:171], a[76:79], v[116:119]
    ds_read_b64_tr_b16 v[190:191], v21 offset:16896
    ds_read_b64_tr_b16 v[192:193], v22 offset:16384
    v_mfma_f32_16x16x32_bf16 v[72:75], v[172:175], a[64:67], v[72:75]
    buffer_load_dwordx4 a[120:123], v34, s[32:35], s48 offen sc1
    v_mfma_f32_16x16x32_bf16 v[88:91], v[172:175], a[68:71], v[88:91]
    ds_read_b64_tr_b16 v[194:195], v22 offset:16896
    v_mfma_f32_16x16x32_bf16 v[104:107], v[172:175], a[72:75], v[104:107]
    v_mfma_f32_16x16x32_bf16 v[120:123], v[172:175], a[76:79], v[120:123]
    v_mfma_f32_16x16x32_bf16 v[76:79], v[176:179], a[64:67], v[76:79]
    buffer_load_dwordx4 a[124:127], v35, s[32:35], s48 offen sc1
    v_mfma_f32_16x16x32_bf16 v[92:95], v[176:179], a[68:71], v[92:95]
    v_mfma_f32_16x16x32_bf16 v[108:111], v[176:179], a[72:75], v[108:111]
    v_mfma_f32_16x16x32_bf16 v[124:127], v[176:179], a[76:79], v[124:127]
    s_waitcnt vmcnt(8) lgkmcnt(0)
    v_mfma_f32_16x16x32_bf16 v[64:67], v[180:183], a[80:83], v[64:67]
    s_add_u32 s48, s70, 32768
    v_mfma_f32_16x16x32_bf16 v[80:83], v[180:183], a[84:87], v[80:83]
    buffer_load_dwordx4 a[128:131], v32, s[32:35], s48 offen sc1
    v_mfma_f32_16x16x32_bf16 v[96:99], v[180:183], a[88:91], v[96:99]
    v_add_u32 v19, 4294836224, v19
    v_add_u32 v20, 4294836224, v20
    v_mfma_f32_16x16x32_bf16 v[112:115], v[180:183], a[92:95], v[112:115]
    v_add_u32 v21, 4294836224, v21
    v_mfma_f32_16x16x32_bf16 v[68:71], v[184:187], a[80:83], v[68:71]
    buffer_load_dwordx4 a[132:135], v33, s[32:35], s48 offen sc1
    v_mfma_f32_16x16x32_bf16 v[84:87], v[184:187], a[84:87], v[84:87]
    v_add_u32 v22, 4294836224, v22
    ds_read_b64_tr_b16 v[164:165], v19 offset:0
    v_mfma_f32_16x16x32_bf16 v[100:103], v[184:187], a[88:91], v[100:103]
    ds_read_b64_tr_b16 v[166:167], v19 offset:512
    v_mfma_f32_16x16x32_bf16 v[116:119], v[184:187], a[92:95], v[116:119]
    ds_read_b64_tr_b16 v[168:169], v20 offset:0
    v_mfma_f32_16x16x32_bf16 v[72:75], v[188:191], a[80:83], v[72:75]
    buffer_load_dwordx4 a[136:139], v34, s[32:35], s48 offen sc1
    v_mfma_f32_16x16x32_bf16 v[88:91], v[188:191], a[84:87], v[88:91]
    ds_read_b64_tr_b16 v[170:171], v20 offset:512
    ds_read_b64_tr_b16 v[172:173], v21 offset:0
    v_mfma_f32_16x16x32_bf16 v[104:107], v[188:191], a[88:91], v[104:107]
    ds_read_b64_tr_b16 v[174:175], v21 offset:512
    v_mfma_f32_16x16x32_bf16 v[120:123], v[188:191], a[92:95], v[120:123]
    ds_read_b64_tr_b16 v[176:177], v22 offset:0
    v_mfma_f32_16x16x32_bf16 v[76:79], v[192:195], a[80:83], v[76:79]
    buffer_load_dwordx4 a[140:143], v35, s[32:35], s48 offen sc1
    v_mfma_f32_16x16x32_bf16 v[92:95], v[192:195], a[84:87], v[92:95]
    ds_read_b64_tr_b16 v[178:179], v22 offset:512
    v_mfma_f32_16x16x32_bf16 v[108:111], v[192:195], a[88:91], v[108:111]
    v_mfma_f32_16x16x32_bf16 v[124:127], v[192:195], a[92:95], v[124:127]
    s_waitcnt vmcnt(8) lgkmcnt(0)
    v_mfma_f32_16x16x32_bf16 v[64:67], v[164:167], a[96:99], v[64:67]
    s_add_u32 s48, s70, 36864
    v_mfma_f32_16x16x32_bf16 v[80:83], v[164:167], a[100:103], v[80:83]
    buffer_load_dwordx4 a[144:147], v32, s[32:35], s48 offen sc1
    v_mfma_f32_16x16x32_bf16 v[96:99], v[164:167], a[104:107], v[96:99]
    ds_read_b64_tr_b16 v[180:181], v19 offset:16384
    v_mfma_f32_16x16x32_bf16 v[112:115], v[164:167], a[108:111], v[112:115]
    ds_read_b64_tr_b16 v[182:183], v19 offset:16896
    ds_read_b64_tr_b16 v[184:185], v20 offset:16384
    v_mfma_f32_16x16x32_bf16 v[68:71], v[168:171], a[96:99], v[68:71]
    buffer_load_dwordx4 a[148:151], v33, s[32:35], s48 offen sc1
    v_mfma_f32_16x16x32_bf16 v[84:87], v[168:171], a[100:103], v[84:87]
    ds_read_b64_tr_b16 v[186:187], v20 offset:16896
    v_mfma_f32_16x16x32_bf16 v[100:103], v[168:171], a[104:107], v[100:103]
    ds_read_b64_tr_b16 v[188:189], v21 offset:16384
    v_mfma_f32_16x16x32_bf16 v[116:119], v[168:171], a[108:111], v[116:119]
    ds_read_b64_tr_b16 v[190:191], v21 offset:16896
    ds_read_b64_tr_b16 v[192:193], v22 offset:16384
    v_mfma_f32_16x16x32_bf16 v[72:75], v[172:175], a[96:99], v[72:75]
    buffer_load_dwordx4 a[152:155], v34, s[32:35], s48 offen sc1
    v_mfma_f32_16x16x32_bf16 v[88:91], v[172:175], a[100:103], v[88:91]
    ds_read_b64_tr_b16 v[194:195], v22 offset:16896
    v_mfma_f32_16x16x32_bf16 v[104:107], v[172:175], a[104:107], v[104:107]
    v_mfma_f32_16x16x32_bf16 v[120:123], v[172:175], a[108:111], v[120:123]
    v_mfma_f32_16x16x32_bf16 v[76:79], v[176:179], a[96:99], v[76:79]
    buffer_load_dwordx4 a[156:159], v35, s[32:35], s48 offen sc1
    v_mfma_f32_16x16x32_bf16 v[92:95], v[176:179], a[100:103], v[92:95]
    v_mfma_f32_16x16x32_bf16 v[108:111], v[176:179], a[104:107], v[108:111]
    v_mfma_f32_16x16x32_bf16 v[124:127], v[176:179], a[108:111], v[124:127]
    s_waitcnt vmcnt(8) lgkmcnt(0)
    v_mfma_f32_16x16x32_bf16 v[64:67], v[180:183], a[112:115], v[64:67]
    s_add_u32 s48, s70, 40960
    v_mfma_f32_16x16x32_bf16 v[80:83], v[180:183], a[116:119], v[80:83]
    buffer_load_dwordx4 a[160:163], v32, s[32:35], s48 offen sc1
    v_mfma_f32_16x16x32_bf16 v[96:99], v[180:183], a[120:123], v[96:99]
    ds_read_b64_tr_b16 v[164:165], v19 offset:32768
    v_mfma_f32_16x16x32_bf16 v[112:115], v[180:183], a[124:127], v[112:115]
    ds_read_b64_tr_b16 v[166:167], v19 offset:33280
    ds_read_b64_tr_b16 v[168:169], v20 offset:32768
    v_mfma_f32_16x16x32_bf16 v[68:71], v[184:187], a[112:115], v[68:71]
    buffer_load_dwordx4 a[164:167], v33, s[32:35], s48 offen sc1
    v_mfma_f32_16x16x32_bf16 v[84:87], v[184:187], a[116:119], v[84:87]
    ds_read_b64_tr_b16 v[170:171], v20 offset:33280
    v_mfma_f32_16x16x32_bf16 v[100:103], v[184:187], a[120:123], v[100:103]
    ds_read_b64_tr_b16 v[172:173], v21 offset:32768
    v_mfma_f32_16x16x32_bf16 v[116:119], v[184:187], a[124:127], v[116:119]
    ds_read_b64_tr_b16 v[174:175], v21 offset:33280
    ds_read_b64_tr_b16 v[176:177], v22 offset:32768
    v_mfma_f32_16x16x32_bf16 v[72:75], v[188:191], a[112:115], v[72:75]
    buffer_load_dwordx4 a[168:171], v34, s[32:35], s48 offen sc1
    v_mfma_f32_16x16x32_bf16 v[88:91], v[188:191], a[116:119], v[88:91]
    ds_read_b64_tr_b16 v[178:179], v22 offset:33280
    v_mfma_f32_16x16x32_bf16 v[104:107], v[188:191], a[120:123], v[104:107]
    v_mfma_f32_16x16x32_bf16 v[120:123], v[188:191], a[124:127], v[120:123]
    v_mfma_f32_16x16x32_bf16 v[76:79], v[192:195], a[112:115], v[76:79]
    buffer_load_dwordx4 a[172:175], v35, s[32:35], s48 offen sc1
    v_mfma_f32_16x16x32_bf16 v[92:95], v[192:195], a[116:119], v[92:95]
    v_mfma_f32_16x16x32_bf16 v[108:111], v[192:195], a[120:123], v[108:111]
    v_mfma_f32_16x16x32_bf16 v[124:127], v[192:195], a[124:127], v[124:127]
    s_waitcnt vmcnt(8) lgkmcnt(0)
    v_mfma_f32_16x16x32_bf16 v[64:67], v[164:167], a[128:131], v[64:67]
    ds_read_b64_tr_b16 v[180:181], v19 offset:49152
    v_mfma_f32_16x16x32_bf16 v[80:83], v[164:167], a[132:135], v[80:83]
    ds_read_b64_tr_b16 v[182:183], v19 offset:49664
    v_mfma_f32_16x16x32_bf16 v[96:99], v[164:167], a[136:139], v[96:99]
    ds_read_b64_tr_b16 v[184:185], v20 offset:49152
    ds_read_b64_tr_b16 v[186:187], v20 offset:49664
    v_mfma_f32_16x16x32_bf16 v[112:115], v[164:167], a[140:143], v[112:115]
    ds_read_b64_tr_b16 v[188:189], v21 offset:49152
    v_mfma_f32_16x16x32_bf16 v[68:71], v[168:171], a[128:131], v[68:71]
    ds_read_b64_tr_b16 v[190:191], v21 offset:49664
    v_mfma_f32_16x16x32_bf16 v[84:87], v[168:171], a[132:135], v[84:87]
    ds_read_b64_tr_b16 v[192:193], v22 offset:49152
    ds_read_b64_tr_b16 v[194:195], v22 offset:49664
    v_mfma_f32_16x16x32_bf16 v[100:103], v[168:171], a[136:139], v[100:103]
    v_mfma_f32_16x16x32_bf16 v[116:119], v[168:171], a[140:143], v[116:119]
    v_mfma_f32_16x16x32_bf16 v[72:75], v[172:175], a[128:131], v[72:75]
    v_mfma_f32_16x16x32_bf16 v[88:91], v[172:175], a[132:135], v[88:91]
    v_mfma_f32_16x16x32_bf16 v[104:107], v[172:175], a[136:139], v[104:107]
    v_mfma_f32_16x16x32_bf16 v[120:123], v[172:175], a[140:143], v[120:123]
    v_mfma_f32_16x16x32_bf16 v[76:79], v[176:179], a[128:131], v[76:79]
    v_mfma_f32_16x16x32_bf16 v[92:95], v[176:179], a[132:135], v[92:95]
    v_mfma_f32_16x16x32_bf16 v[108:111], v[176:179], a[136:139], v[108:111]
    v_mfma_f32_16x16x32_bf16 v[124:127], v[176:179], a[140:143], v[124:127]
    s_waitcnt vmcnt(4) lgkmcnt(0)
    v_mfma_f32_16x16x32_bf16 v[64:67], v[180:183], a[144:147], v[64:67]
    v_add_u32 v19, 65536, v19
    v_mfma_f32_16x16x32_bf16 v[80:83], v[180:183], a[148:151], v[80:83]
    v_add_u32 v20, 65536, v20
    v_mfma_f32_16x16x32_bf16 v[96:99], v[180:183], a[152:155], v[96:99]
    v_add_u32 v21, 65536, v21
    v_add_u32 v22, 65536, v22
    v_mfma_f32_16x16x32_bf16 v[112:115], v[180:183], a[156:159], v[112:115]
    ds_read_b64_tr_b16 v[164:165], v19 offset:0
    v_mfma_f32_16x16x32_bf16 v[68:71], v[184:187], a[144:147], v[68:71]
    ds_read_b64_tr_b16 v[166:167], v19 offset:512
    v_mfma_f32_16x16x32_bf16 v[84:87], v[184:187], a[148:151], v[84:87]
    ds_read_b64_tr_b16 v[168:169], v20 offset:0
    ds_read_b64_tr_b16 v[170:171], v20 offset:512
    v_mfma_f32_16x16x32_bf16 v[100:103], v[184:187], a[152:155], v[100:103]
    ds_read_b64_tr_b16 v[172:173], v21 offset:0
    v_mfma_f32_16x16x32_bf16 v[116:119], v[184:187], a[156:159], v[116:119]
    ds_read_b64_tr_b16 v[174:175], v21 offset:512
    v_mfma_f32_16x16x32_bf16 v[72:75], v[188:191], a[144:147], v[72:75]
    ds_read_b64_tr_b16 v[176:177], v22 offset:0
    ds_read_b64_tr_b16 v[178:179], v22 offset:512
    v_mfma_f32_16x16x32_bf16 v[88:91], v[188:191], a[148:151], v[88:91]
    v_mfma_f32_16x16x32_bf16 v[104:107], v[188:191], a[152:155], v[104:107]
    v_mfma_f32_16x16x32_bf16 v[120:123], v[188:191], a[156:159], v[120:123]
    v_mfma_f32_16x16x32_bf16 v[76:79], v[192:195], a[144:147], v[76:79]
    v_mfma_f32_16x16x32_bf16 v[92:95], v[192:195], a[148:151], v[92:95]
    v_mfma_f32_16x16x32_bf16 v[108:111], v[192:195], a[152:155], v[108:111]
    v_mfma_f32_16x16x32_bf16 v[124:127], v[192:195], a[156:159], v[124:127]
    s_waitcnt vmcnt(0) lgkmcnt(0)
    v_mfma_f32_16x16x32_bf16 v[80:83], v[164:167], a[164:167], v[80:83]
    v_mfma_f32_16x16x32_bf16 v[84:87], v[168:171], a[164:167], v[84:87]
    v_mfma_f32_16x16x32_bf16 v[88:91], v[172:175], a[164:167], v[88:91]
    v_mfma_f32_16x16x32_bf16 v[92:95], v[176:179], a[164:167], v[92:95]
    v_mfma_f32_16x16x32_bf16 v[96:99], v[164:167], a[168:171], v[96:99]
    v_mfma_f32_16x16x32_bf16 v[100:103], v[168:171], a[168:171], v[100:103]
    v_mfma_f32_16x16x32_bf16 v[104:107], v[172:175], a[168:171], v[104:107]
    v_mfma_f32_16x16x32_bf16 v[108:111], v[176:179], a[168:171], v[108:111]
    s_nop 0
    ds_write_b128 v39, v[80:83] offset:0
    v_mfma_f32_16x16x32_bf16 v[112:115], v[164:167], a[172:175], v[112:115]
    ds_write_b128 v39, v[84:87] offset:1024
    v_mfma_f32_16x16x32_bf16 v[116:119], v[168:171], a[172:175], v[116:119]
    ds_write_b128 v39, v[88:91] offset:2048
    v_mfma_f32_16x16x32_bf16 v[120:123], v[172:175], a[172:175], v[120:123]
    ds_write_b128 v39, v[92:95] offset:3072
    v_mfma_f32_16x16x32_bf16 v[124:127], v[176:179], a[172:175], v[124:127]
    ds_write_b128 v39, v[96:99] offset:16384
    v_mfma_f32_16x16x32_bf16 v[64:67], v[164:167], a[160:163], v[64:67]
    ds_write_b128 v39, v[100:103] offset:17408
    v_mfma_f32_16x16x32_bf16 v[68:71], v[168:171], a[160:163], v[68:71]
    ds_write_b128 v39, v[104:107] offset:18432
    v_mfma_f32_16x16x32_bf16 v[72:75], v[172:175], a[160:163], v[72:75]
    ds_write_b128 v39, v[108:111] offset:19456
    v_mfma_f32_16x16x32_bf16 v[76:79], v[176:179], a[160:163], v[76:79]
    ds_write_b128 v39, v[112:115] offset:32768
    ds_write_b128 v39, v[116:119] offset:33792
    ds_write_b128 v39, v[120:123] offset:34816
    ds_write_b128 v39, v[124:127] offset:35840
    s_waitcnt lgkmcnt(0)
    s_barrier
    ds_read_b128 v[164:167], v36 offset:0
    ds_read_b128 v[168:171], v36 offset:1024
    ds_read_b128 v[172:175], v36 offset:2048
    ds_read_b128 v[176:179], v36 offset:3072
    ds_read_b128 v[180:183], v37 offset:0
    ds_read_b128 v[184:187], v37 offset:1024
    ds_read_b128 v[188:191], v37 offset:2048
    ds_read_b128 v[192:195], v37 offset:3072
    ds_read_b128 v[196:199], v38 offset:0
    ds_read_b128 v[200:203], v38 offset:1024
    ds_read_b128 v[204:207], v38 offset:2048
    ds_read_b128 v[208:211], v38 offset:3072
    s_waitcnt lgkmcnt(8)
    v_pk_add_f32 v[64:65], v[64:65], v[164:165]
    v_pk_add_f32 v[66:67], v[66:67], v[166:167]
    v_pk_add_f32 v[68:69], v[68:69], v[168:169]
    v_pk_add_f32 v[70:71], v[70:71], v[170:171]
    v_pk_add_f32 v[72:73], v[72:73], v[172:173]
    v_pk_add_f32 v[74:75], v[74:75], v[174:175]
    v_pk_add_f32 v[76:77], v[76:77], v[176:177]
    v_pk_add_f32 v[78:79], v[78:79], v[178:179]
    s_waitcnt lgkmcnt(4)
    v_pk_add_f32 v[64:65], v[64:65], v[180:181]
    v_pk_add_f32 v[66:67], v[66:67], v[182:183]
    v_pk_add_f32 v[68:69], v[68:69], v[184:185]
    v_pk_add_f32 v[70:71], v[70:71], v[186:187]
    v_pk_add_f32 v[72:73], v[72:73], v[188:189]
    v_pk_add_f32 v[74:75], v[74:75], v[190:191]
    v_pk_add_f32 v[76:77], v[76:77], v[192:193]
    v_pk_add_f32 v[78:79], v[78:79], v[194:195]
    s_waitcnt lgkmcnt(0)
    v_pk_add_f32 v[64:65], v[64:65], v[196:197]
    v_pk_add_f32 v[66:67], v[66:67], v[198:199]
    v_pk_add_f32 v[68:69], v[68:69], v[200:201]
    v_pk_add_f32 v[70:71], v[70:71], v[202:203]
    v_pk_add_f32 v[72:73], v[72:73], v[204:205]
    v_pk_add_f32 v[74:75], v[74:75], v[206:207]
    v_pk_add_f32 v[76:77], v[76:77], v[208:209]
    v_pk_add_f32 v[78:79], v[78:79], v[210:211]
    v_cvt_pk_bf16_f32 v128, v64, v65
    v_cvt_pk_bf16_f32 v129, v66, v67
    v_cvt_pk_bf16_f32 v130, v68, v69
    v_cvt_pk_bf16_f32 v131, v70, v71
    v_cvt_pk_bf16_f32 v132, v72, v73
    v_cvt_pk_bf16_f32 v133, v74, v75
    v_cvt_pk_bf16_f32 v134, v76, v77
    v_cvt_pk_bf16_f32 v135, v78, v79
    v_permlane16_swap_b32 v128, v130
    v_permlane16_swap_b32 v129, v131
    v_permlane16_swap_b32 v132, v134
    v_permlane16_swap_b32 v133, v135
    buffer_store_dwordx4 v[128:131], v31, s[24:27], s67 offen offset:0 sc1
    buffer_store_dwordx4 v[132:135], v31, s[24:27], s67 offen offset:64 sc1
L_end:
    s_endpgm
L_rdy_wait:
    s_add_u32 s53, s53, 1
    s_cmp_lt_u32 s53, 0x40000
    s_cbranch_scc0 L_end
    s_lshl_b32 s40, s44, 3
    buffer_load_dwordx2 v[234:235], off, s[36:39], s40 sc1
    s_waitcnt vmcnt(0)
    s_branch L_rdy
L_pub_slow1:
    buffer_store_dword v62, v29, s[28:31], 0 offen sc1
    s_branch L_pub_done1
L_acq_slow1:
    buffer_inv sc1
    s_waitcnt vmcnt(0)
    s_branch L_acq_done1
L_pub_slow2:
    buffer_store_dword v62, v29, s[28:31], 0 offen sc1
    s_branch L_pub_done2
L_acq_slow2:
    buffer_inv sc1
    s_waitcnt vmcnt(0)
    s_branch L_acq_done2
L_pub_slow3:
    buffer_store_dword v62, v29, s[28:31], 0 offen sc1
    s_branch L_pub_done3
L_acq_slow3:
    buffer_inv sc1
    s_waitcnt vmcnt(0)
    s_branch L_acq_done3
L_code_end:
    s_endpgm
.p2align 6
L_table:
    .long 0x55505555
    .long 0x50005500
    .long 0xaaa0aaaa
    .long 0xa000aa00
    .long 0x55405554
    .long 0x40005400
    .long 0xaa80aaa8
    .long 0x8000a800
    .long 0x00050000
    .long 0x05550055
    .long 0x000a0000
    .long 0x0aaa00aa
    .long 0x00150001
    .long 0x15550155
    .long 0x002a0002
    .long 0x2aaa02aa
    .long 0x22222222
    .long 0x22222222
    .long 0x44444444
    .long 0x44444444
    .long 0x88888888
    .long 0x88888888
    .long 0x00f0000f
    .long 0xf0000f00
    .long 0x0000ffff
    .long 0x00000000
    .long 0x3b000000
    .long 0xbb000000
    .long 0x3727c5ac
    .long 0x3eb8aa3b
    .long 0xbfb8aa3b
    .long 0x00000000
.section .rodata,"a"
.p2align 6
.amdhsa_kernel sequential_preLN__sliding_local_dilated__dense_activation_silu__prompt_kernel
  .amdhsa_next_free_vgpr 512
  .amdhsa_next_free_sgpr 102
  .amdhsa_accum_offset 256
  .amdhsa_group_segment_fixed_size 0
  .amdhsa_kernarg_size 72
  .amdhsa_user_sgpr_count 2
  .amdhsa_user_sgpr_kernarg_segment_ptr 1
  .amdhsa_system_sgpr_workgroup_id_x 1
.end_amdhsa_kernel
```
